```python
import torch

def _softmax(x, axis=-1):
    return torch.softmax(x, dim=axis)
def _gelu(x):
    return torch.nn.functional.gelu(x, approximate="tanh")
def _silu(x):
    return torch.nn.functional.silu(x)
def _sigmoid(x):
    return torch.sigmoid(x)
def _layernorm(x, axis=-1, eps=1e-5):
    m = x.mean(dim=axis, keepdim=True)
    v = x.var(dim=axis, keepdim=True, unbiased=False)
    return (x - m) / torch.sqrt(v + eps)
def _scatter_add(tgt, idx, src, axis=0):
    return tgt.clone().index_add_(axis, idx, src)
def _segment_sum(src, seg, n):
    out = torch.zeros((n,) + src.shape[1:], dtype=src.dtype)
    return out.index_add_(0, seg, src)
def _pad(x, pw):
    flat = tuple(v for pair in reversed(pw) for v in pair)
    return torch.nn.functional.pad(x, flat)

kernel_name = 'parallel_sum__ssm_conv_s5__geglu_ffn__prompt'

def setup_inputs():

    _w = (lambda a: (lambda t: t.to(torch.bfloat16) if t.is_floating_point() else t)(torch.as_tensor(a)))
    def _A_setup():
        B, S, D = 1, 2048, 512
        P = D
        Lambda_re = -0.5 * (lambda _x: torch.exp(torch.as_tensor(_x)))((lambda *s: torch.randn(*s, dtype=torch.bfloat16) * 0.8)(P))
        Lambda_im = (lambda *s: torch.randn(*s, dtype=torch.bfloat16) * 0.8)(P) * 1.0
        B_re = (lambda *s: torch.randn(*s, dtype=torch.bfloat16) * 0.8)(P, D) * (D ** -0.5)
        B_im = (lambda *s: torch.randn(*s, dtype=torch.bfloat16) * 0.8)(P, D) * (D ** -0.5)
        C_re = (lambda *s: torch.randn(*s, dtype=torch.bfloat16) * 0.8)(D, P) * (P ** -0.5)
        C_im = (lambda *s: torch.randn(*s, dtype=torch.bfloat16) * 0.8)(D, P) * (P ** -0.5)
        log_dt = (lambda *s: torch.randn(*s, dtype=torch.bfloat16) * 0.8)(P) * 0.3 - 2.0
        Dskip = (lambda *s: torch.randn(*s, dtype=torch.bfloat16) * 0.8)(D)
        return {
            "x": _w((lambda *s: torch.randn(*s, dtype=torch.bfloat16) * 0.05)(B, S, D)),
            "Lambda_re": _w(Lambda_re),
            "Lambda_im": _w(Lambda_im),
            "B_re": _w(B_re),
            "B_im": _w(B_im),
            "C_re": _w(C_re),
            "C_im": _w(C_im),
            "log_dt": _w(log_dt),
            "Dskip": _w(Dskip),
        }
    _A_in = _A_setup()

    def _B_setup():
        B, S, D, F = 1, 2048, 512, 1376
        return {
            "x": _w((lambda *s: torch.randn(*s, dtype=torch.bfloat16) * 0.05)(B, S, D)),
            "w_gate": _w((lambda *s: torch.randn(*s, dtype=torch.bfloat16) * 0.05)(D, F)),
            "w_up": _w((lambda *s: torch.randn(*s, dtype=torch.bfloat16) * 0.05)(D, F)),
            "w_down": _w((lambda *s: torch.randn(*s, dtype=torch.bfloat16) * 0.05)(F, D)),
        }
    _B_in = _B_setup()

    return {
        "A_x": _A_in["x"],
        "A_Lambda_re": _A_in["Lambda_re"],
        "A_Lambda_im": _A_in["Lambda_im"],
        "A_B_re": _A_in["B_re"],
        "A_B_im": _A_in["B_im"],
        "A_C_re": _A_in["C_re"],
        "A_C_im": _A_in["C_im"],
        "A_log_dt": _A_in["log_dt"],
        "A_Dskip": _A_in["Dskip"],
        "B_x": _B_in["x"],
        "B_w_gate": _B_in["w_gate"],
        "B_w_up": _B_in["w_up"],
        "B_w_down": _B_in["w_down"],
    }

def reference(A_x, A_Lambda_re, A_Lambda_im, A_B_re, A_B_im, A_C_re, A_C_im, A_log_dt, A_Dskip, B_x, B_w_gate, B_w_up, B_w_down):
    def _A_ref(x, Lambda_re, Lambda_im, B_re, B_im, C_re, C_im, log_dt, Dskip):
        Bsz, L, H = x.shape
        Lam = Lambda_re + 1j * Lambda_im
        Bmat = B_re + 1j * B_im
        Cmat = C_re + 1j * C_im
        dt = torch.exp(log_dt)
        Lam_bar = torch.exp(dt * Lam)
        B_bar = ((Lam_bar - 1.0) / Lam)[:, None] * Bmat
        Bu = torch.einsum("bld,pd->blp", x + 0j, B_bar)
        h = torch.zeros_like(Bu[:, 0, :])
        hs = []
        for t in range(L):
            h = Lam_bar[None, :] * h + Bu[:, t, :]
            hs.append(h)
        hseq = torch.stack(hs, 1)
        y = 2.0 * torch.einsum("blp,dp->bld", hseq, Cmat).real + x * Dskip[None, None, :]
        return y

    def _B_ref(x, w_gate, w_up, w_down):
        return (_gelu(x @ w_gate) * (x @ w_up)) @ w_down

    x = A_x
    xn = _layernorm(x, axis=-1)
    return x + _A_ref(xn, A_Lambda_re, A_Lambda_im, A_B_re, A_B_im, A_C_re, A_C_im, A_log_dt, A_Dskip) + _B_ref(xn, B_w_gate, B_w_up, B_w_down)
```

```asm
; @launch grid=(256,1,1) block=(512,1,1) lds=163840
.amdgcn_target "amdgcn-amd-amdhsa--gfx950"
.text
.p2align 12
.globl parallel_sum__ssm_conv_s5__geglu_ffn__prompt_kernel
.p2align 8
.type parallel_sum__ssm_conv_s5__geglu_ffn__prompt_kernel,@function
parallel_sum__ssm_conv_s5__geglu_ffn__prompt_kernel:
  s_cmp_ge_u32 s2, 256
  s_cbranch_scc1 L_end
  s_load_dwordx16 s[36:51], s[0:1], 0
  s_load_dwordx16 s[52:67], s[0:1], 64
  s_getpc_b64 s[72:73]
L_pc0:
  v_lshrrev_b32 v3, 6, v0
  s_and_b32 s3, s2, 0xf8
  v_add_lshl_u32 v2, v3, s3, 7
  v_min_u32 v2, L_last-L_pc0, v2
  v_and_b32 v1, 63, v0
  v_readfirstlane_b32 s76, v3
  global_load_dword v9, v2, s[72:73]
  s_bfe_u32 s86, s2, 0x20003
  s_lshr_b32 s87, s2, 5
  s_and_b32 s90, s2, 1
  s_lshl_b32 s79, s90, 2
  s_bfe_u32 s91, s2, 0x20001
  s_xor_b32 s85, s79, 4
  s_add_u32 s85, s85, s91
  s_add_u32 s79, s79, s86
  s_lshl_b32 s80, s91, 3
  s_add_u32 s80, s80, s87
  s_xor_b32 s80, s80, 4
  s_and_b32 s85, s85, 4
  s_and_b32 s92, s91, 1
  s_lshl_b32 s92, s92, 1
  s_add_u32 s85, s85, s92
  s_lshr_b32 s92, s87, 2
  s_add_u32 s85, s85, s92
  s_and_b32 s87, s87, 3
  s_and_b32 s92, s91, 2
  s_lshl_b32 s92, s92, 1
  s_add_u32 s87, s87, s92
  s_and_b32 s77, s76, 3
  s_lshr_b32 s78, s76, 2
  s_lshl_b32 s94, s79, 2
  s_add_u32 s94, s94, s77
  s_mul_i32 s95, s77, 24576
  v_lshrrev_b32 v4, 3, v1
  v_and_b32 v5, 7, v1
  s_cmp_eq_u32 s78, 0
  s_cbranch_scc0 L_load
  s_setprio 2
  v_and_b32 v3, 15, v1
  s_lshl_b32 s91, s80, 5
  v_lshl_add_u32 v3, v3, 1, s91
  s_lshl_b32 s90, s77, 2
  s_add_u32 s90, s90, 163584
  v_mov_b32 v10, s90
  v_mov_b32 v11, 0
  ds_write_b32 v10, v11
  s_lshl_b32 s90, s79, 5
  s_add_u32 s90, s90, s80
  s_lshl_b32 s90, s90, 2
  s_add_u32 s72, s90, s77
  s_lshl_b32 s92, s72, 11
  v_and_b32 v2, 31, v1
  v_lshl_add_u32 v2, v2, 4, s92
  v_and_b32 v6, 32, v1
  v_lshl_add_u32 v2, v6, 5, v2
  s_waitcnt lgkmcnt(0)
  global_load_ushort v244, v3, s[38:39]
  global_load_ushort v245, v3, s[40:41]
  global_load_ushort v246, v3, s[50:51]
  global_load_dwordx4 v[112:115], v2, s[36:37]
  global_load_dwordx4 v[116:119], v2, s[36:37] offset:512
  s_setprio 0
  s_branch L_comp
L_load:
  s_setprio 1
  s_mov_b32 s81, 0x37654210
  s_cmp_eq_u32 s90, 1
  s_cselect_b32 s81, 0x32107654, s81
  v_lshrrev_b32 v6, 2, v4
  v_lshlrev_b32 v6, 4, v6
  v_and_or_b32 v6, v4, 3, v6
  s_lshl_b32 s90, s94, 6
  v_add_u32 v6, s90, v6
  v_lshlrev_b32 v6, 10, v6
  v_lshrrev_b32 v7, 1, v4
  v_xor_b32 v7, v5, v7
  v_xor_b32 v8, 4, v7
  v_lshl_add_u32 v16, v7, 4, v6
  v_lshl_add_u32 v17, v8, 4, v6
  v_add_u32 v17, 31744, v17
  v_add_u32 v18, 2048, v16
  v_add_u32 v19, 2048, v17
  s_and_b32 s76, s80, 1
  s_lshl_b32 s83, s76, 12
  s_add_u32 s83, s83, s95
  s_lshl_b32 s76, s76, 13
  s_mov_b32 s6, 2097152
  s_mov_b32 s7, 0x20000
  s_waitcnt lgkmcnt(0)
  s_mov_b32 s4, s36
  s_mov_b32 s5, s37
  s_bfe_u32 s90, s81, 196608
  s_lshl_b32 s88, s90, 7
  s_add_u32 m0, s83, 0
  s_add_u32 s88, s88, s76
  buffer_load_dwordx4 v16, s[4:7], s88 offen lds
  buffer_load_dwordx4 v17, s[4:7], s88 offen offset:1024 lds
  buffer_load_dwordx4 v18, s[4:7], s88 offen offset:2048 lds
  buffer_load_dwordx4 v19, s[4:7], s88 offen offset:3072 lds
  s_lshr_b32 s90, s80, 3
  s_mul_i32 s3, s90, 22
  s_cmp_eq_u32 s90, 3
  s_subb_u32 s3, s3, 0
  s_cmp_lt_u32 s90, 2
  s_cselect_b32 s74, 1, 0
  s_and_b32 s90, s80, 7
  s_cmp_lt_u32 s90, 7
  s_cselect_b32 s74, 3, s74
  s_mul_i32 s90, s90, 3
  s_add_u32 s3, s3, s90
  s_lshl_b32 s92, s3, 5
  s_lshl_b32 s93, s74, 1
  s_and_b32 s98, s79, 1
  s_lshl_b32 s98, s98, 2
  s_add_u32 s98, s98, s77
  s_lshl_b32 s91, s80, 4
  v_add_u32 v6, s91, v4
  v_lshlrev_b32 v6, 10, v6
  v_lshl_add_u32 v2, v7, 4, v6
  v_lshl_add_u32 v3, v8, 4, v6
  v_add_u32 v3, 7168, v3
  v_mov_b32 v0, 0x80000000
  s_cmp_ge_u32 s98, 5
  s_cselect_b32 s97, 5, 2
  s_cselect_b32 s91, 128, 0
  s_cselect_b32 s8, s58, s56
  s_cselect_b32 s9, s59, s57
  s_sub_u32 s97, s98, s97
  s_lshl_b32 s97, s97, 7
  v_add_u32 v6, s97, v1
  v_mul_u32_u24 v10, 10923, v6
  v_lshrrev_b32 v10, 16, v10
  v_mul_u32_u24 v11, 6, v10
  v_sub_u32 v11, v6, v11
  v_lshrrev_b32 v6, 1, v10
  v_xor_b32 v6, v6, v10
  v_and_b32 v6, 4, v6
  v_mul_u32_u24 v6, 3, v6
  v_xor_b32 v10, v10, v6
  v_mul_u32_u24 v10, 2752, v10
  v_lshl_add_u32 v10, v11, 4, v10
  v_cmp_gt_u32 vcc, s93, v11
  v_add_u32 v10, s92, v10
  s_nop 0
  v_cndmask_b32 v20, v0, v10, vcc
  v_add_u32 v6, s97, v1
  v_add_u32 v6, 64, v6
  v_mul_u32_u24 v10, 10923, v6
  v_lshrrev_b32 v10, 16, v10
  v_mul_u32_u24 v11, 6, v10
  v_sub_u32 v11, v6, v11
  v_lshrrev_b32 v6, 1, v10
  v_xor_b32 v6, v6, v10
  v_and_b32 v6, 4, v6
  v_mul_u32_u24 v6, 3, v6
  v_xor_b32 v10, v10, v6
  v_mul_u32_u24 v10, 2752, v10
  v_lshl_add_u32 v10, v11, 4, v10
  v_cmp_gt_u32 vcc, s93, v11
  v_add_u32 v10, s92, v10
  v_subrev_u32 v10, 1024, v10
  v_cndmask_b32 v21, v0, v10, vcc
  s_lshl_b32 s84, s98, 11
  s_add_u32 s84, s84, s91
  s_add_u32 s84, s84, 98304
  s_cmp_eq_u32 s98, 0
  s_cselect_b32 s8, s42, s8
  s_cselect_b32 s9, s43, s9
  s_cmp_eq_u32 s98, 1
  s_cselect_b32 s8, s44, s8
  s_cselect_b32 s9, s45, s9
  s_mov_b32 s82, 176128
  s_mov_b32 s10, 1409024
  s_cmp_lt_u32 s98, 2
  s_cselect_b64 vcc, -1, 0
  s_cselect_b32 s82, 128, s82
  s_cselect_b32 s10, 524288, s10
  s_mov_b32 s11, 0x20000
  v_cndmask_b32 v20, v20, v2, vcc
  v_cndmask_b32 v21, v21, v3, vcc
  s_bfe_u32 s90, s81, 196608
  s_add_u32 m0, s84, 0
  s_mul_i32 s89, s90, s82
  buffer_load_dwordx4 v20, s[8:11], s89 offen lds
  buffer_load_dwordx4 v21, s[8:11], s89 offen offset:1024 lds
  s_xor_b32 s90, s83, 4096
  s_add_u32 m0, s90, 0
  s_xor_b32 s88, s88, 8192
  buffer_load_dwordx4 v16, s[4:7], s88 offen lds
  buffer_load_dwordx4 v17, s[4:7], s88 offen offset:1024 lds
  buffer_load_dwordx4 v18, s[4:7], s88 offen offset:2048 lds
  buffer_load_dwordx4 v19, s[4:7], s88 offen offset:3072 lds
  s_xor_b32 s98, s98, 4
  s_cmp_ge_u32 s98, 5
  s_cselect_b32 s97, 5, 2
  s_cselect_b32 s91, 128, 0
  s_cselect_b32 s32, s58, s56
  s_cselect_b32 s33, s59, s57
  s_sub_u32 s97, s98, s97
  s_lshl_b32 s97, s97, 7
  v_add_u32 v6, s97, v1
  v_mul_u32_u24 v10, 10923, v6
  v_lshrrev_b32 v10, 16, v10
  v_mul_u32_u24 v11, 6, v10
  v_sub_u32 v11, v6, v11
  v_lshrrev_b32 v6, 1, v10
  v_xor_b32 v6, v6, v10
  v_and_b32 v6, 4, v6
  v_mul_u32_u24 v6, 3, v6
  v_xor_b32 v10, v10, v6
  v_mul_u32_u24 v10, 2752, v10
  v_lshl_add_u32 v10, v11, 4, v10
  v_cmp_gt_u32 vcc, s93, v11
  v_add_u32 v10, s92, v10
  s_nop 0
  v_cndmask_b32 v22, v0, v10, vcc
  v_add_u32 v6, s97, v1
  v_add_u32 v6, 64, v6
  v_mul_u32_u24 v10, 10923, v6
  v_lshrrev_b32 v10, 16, v10
  v_mul_u32_u24 v11, 6, v10
  v_sub_u32 v11, v6, v11
  v_lshrrev_b32 v6, 1, v10
  v_xor_b32 v6, v6, v10
  v_and_b32 v6, 4, v6
  v_mul_u32_u24 v6, 3, v6
  v_xor_b32 v10, v10, v6
  v_mul_u32_u24 v10, 2752, v10
  v_lshl_add_u32 v10, v11, 4, v10
  v_cmp_gt_u32 vcc, s93, v11
  v_add_u32 v10, s92, v10
  v_subrev_u32 v10, 1024, v10
  v_cndmask_b32 v23, v0, v10, vcc
  s_lshl_b32 s54, s98, 11
  s_add_u32 s54, s54, s91
  s_add_u32 s54, s54, 98304
  s_cmp_eq_u32 s98, 0
  s_cselect_b32 s32, s42, s32
  s_cselect_b32 s33, s43, s33
  s_cmp_eq_u32 s98, 1
  s_cselect_b32 s32, s44, s32
  s_cselect_b32 s33, s45, s33
  s_mov_b32 s55, 176128
  s_mov_b32 s34, 1409024
  s_cmp_lt_u32 s98, 2
  s_cselect_b64 vcc, -1, 0
  s_cselect_b32 s55, 128, s55
  s_cselect_b32 s34, 524288, s34
  s_mov_b32 s35, 0x20000
  v_cndmask_b32 v22, v22, v2, vcc
  v_cndmask_b32 v23, v23, v3, vcc
  s_bfe_u32 s90, s81, 196608
  s_add_u32 m0, s54, 0
  s_mul_i32 s89, s90, s55
  buffer_load_dwordx4 v22, s[32:35], s89 offen lds
  buffer_load_dwordx4 v23, s[32:35], s89 offen offset:1024 lds
  s_lshl_b32 s91, s2, 2
  s_add_u32 s91, s91, s77
  s_cmp_eq_u32 s91, 391
  s_cbranch_scc1 L_init
L_initd:
  s_lshl_b32 s91, s87, 7
  v_and_b32 v3, 31, v1
  v_lshl_add_u32 v3, v3, 1, s91
  global_load_ushort v40, v3, s[52:53]
  global_load_ushort v41, v3, s[52:53] offset:64
  s_bfe_u32 s90, s81, 196612
  s_lshl_b32 s88, s90, 7
  s_add_u32 m0, s83, 8192
  s_add_u32 s88, s88, s76
  buffer_load_dwordx4 v16, s[4:7], s88 offen lds
  buffer_load_dwordx4 v17, s[4:7], s88 offen offset:1024 lds
  buffer_load_dwordx4 v18, s[4:7], s88 offen offset:2048 lds
  buffer_load_dwordx4 v19, s[4:7], s88 offen offset:3072 lds
  s_mov_b32 s12, s66
  s_mov_b32 s13, s67
  s_mov_b32 s14, 11010048
  s_mov_b32 s15, 0x20000
  s_mov_b32 s28, s60
  s_mov_b32 s29, s61
  s_mov_b32 s30, 1409024
  s_mov_b32 s31, 0x20000
  v_lshlrev_b32 v6, 1, v4
  v_and_b32 v6, 4, v6
  v_xor_b32 v6, v5, v6
  v_lshlrev_b32 v6, 4, v6
  v_lshl_add_u32 v6, v4, 10, v6
  s_lshl_b32 s90, s87, 7
  v_add_u32 v14, s90, v6
  s_mul_i32 s93, s77, 22
  s_cmp_eq_u32 s77, 3
  s_cselect_b32 s90, 1, 0
  s_sub_u32 s93, s93, s90
  s_lshl_b32 s75, s93, 14
  s_lshl_b32 s96, s77, 12
  s_lshl_b32 s90, s90, 11
  s_sub_u32 s99, s96, s90
  s_add_u32 s99, s99, 148224
  s_add_u32 s96, s96, 98304
  s_lshl_b32 s98, s94, 2
  s_lshr_b32 s90, s80, 3
  s_add_u32 s98, s98, s90
  s_lshl_b32 s98, s98, 8
  s_add_u32 s98, s98, 10616832
  v_lshlrev_b32 v15, 4, v1
  v_and_b32 v2, 15, v1
  v_lshrrev_b32 v3, 4, v1
  v_bfe_u32 v6, v1, 1, 3
  v_xor_b32 v6, v3, v6
  v_lshlrev_b32 v6, 4, v6
  v_lshl_add_u32 v6, v2, 7, v6
  v_bfe_u32 v10, v1, 2, 3
  v_lshrrev_b32 v11, 5, v1
  v_lshl_add_u32 v10, v11, 4, v10
  v_mul_u32_u24 v10, 96, v10
  v_and_b32 v11, 3, v1
  v_lshl_add_u32 v10, v11, 3, v10
  s_mov_b32 s20, s46
  s_mov_b32 s21, s47
  s_mov_b32 s22, 524288
  s_mov_b32 s23, 0x20000
  s_mov_b32 s24, s48
  s_mov_b32 s25, s49
  s_mov_b32 s26, 524288
  s_mov_b32 s27, 0x20000
  s_mov_b32 s16, s64
  s_mov_b32 s17, s65
  s_mov_b32 s18, 256
  s_mov_b32 s19, 0x20000
  s_mov_b32 s68, s62
  s_mov_b32 s69, s63
  s_mov_b32 s70, 4194304
  s_mov_b32 s71, 0x20000
  s_lshl_b32 s73, s77, 8
  s_cmp_eq_u32 s77, 0
  s_cselect_b32 s0, 1, 0
  s_cselect_b32 s1, 0, 0x40000000
  s_lshl_b32 s92, s77, 5
  s_add_u32 s92, s92, 102368
  v_add_u32 v30, s92, v10
  v_add_u32 v29, 98304, v6
  v_xor_b32 v244, 64, v29
  v_mov_b32 v3, 0x3f803f80
  v_cmp_eq_u32 vcc, 0, v2
  s_nop 1
  v_cndmask_b32 v208, 0, v3, vcc
  v_cndmask_b32 v209, 0, v3, vcc
  v_cndmask_b32 v210, 0, v3, vcc
  v_cndmask_b32 v211, 0, v3, vcc
  v_cmp_eq_u32 vcc, 1, v2
  s_nop 1
  v_cndmask_b32 v212, 0, v3, vcc
  v_cndmask_b32 v213, 0, v3, vcc
  v_cndmask_b32 v214, 0, v3, vcc
  v_cndmask_b32 v215, 0, v3, vcc
  s_bfe_u32 s90, s81, 196612
  s_add_u32 m0, s84, 16640
  s_mul_i32 s89, s90, s82
  buffer_load_dwordx4 v20, s[8:11], s89 offen lds
  v_mov_b64 v[52:53], 0
  v_mov_b64 v[54:55], 0
  v_mov_b64 v[56:57], 0
  v_mov_b64 v[58:59], 0
  v_mov_b64 v[60:61], 0
  v_mov_b64 v[62:63], 0
  v_mov_b64 v[68:69], 0
  v_mov_b64 v[70:71], 0
  buffer_load_dwordx4 v21, s[8:11], s89 offen offset:1024 lds
  v_mov_b64 v[72:73], 0
  v_mov_b64 v[74:75], 0
  v_mov_b64 v[76:77], 0
  v_mov_b64 v[78:79], 0
  v_mov_b64 v[84:85], 0
  v_mov_b64 v[86:87], 0
  v_mov_b64 v[88:89], 0
  v_mov_b64 v[90:91], 0
  s_xor_b32 s90, s83, 4096
  s_add_u32 m0, s90, 8192
  s_xor_b32 s88, s88, 8192
  buffer_load_dwordx4 v16, s[4:7], s88 offen lds
  v_mov_b64 v[92:93], 0
  v_mov_b64 v[94:95], 0
  v_mov_b64 v[100:101], 0
  v_mov_b64 v[102:103], 0
  v_mov_b64 v[104:105], 0
  v_mov_b64 v[106:107], 0
  v_mov_b64 v[108:109], 0
  v_mov_b64 v[110:111], 0
  buffer_load_dwordx4 v17, s[4:7], s88 offen offset:1024 lds
  s_setprio 1
  s_waitcnt vmcnt(10)
  s_barrier
  s_lshl_b32 s91, s2, 2
  s_add_u32 s91, s91, s77
  s_cmp_eq_u32 s91, 391
  s_cbranch_scc1 L_init2
L_init2d:
  buffer_load_dwordx4 v18, s[4:7], s88 offen offset:2048 lds
  buffer_load_dwordx4 v19, s[4:7], s88 offen offset:3072 lds
  s_bfe_u32 s90, s81, 196612
  s_add_u32 m0, s54, 16640
  s_mul_i32 s89, s90, s55
  buffer_load_dwordx4 v22, s[32:35], s89 offen lds
  s_cmp_eq_u32 s77, 0
  s_cbranch_scc0 L_sb0
  ds_read_b128 v[224:227], v29 offset:0
  ds_read_b128 v[228:231], v29 offset:2048
  ds_read_b128 v[232:235], v244 offset:0
  ds_read_b128 v[236:239], v244 offset:2048
  s_branch L_sd0
L_sb0:
  ds_read_b64_tr_b16 v[224:225], v30 offset:0
  ds_read_b64_tr_b16 v[226:227], v30 offset:768
  ds_read_b64_tr_b16 v[228:229], v30 offset:6272
  ds_read_b64_tr_b16 v[230:231], v30 offset:7040
  ds_read_b64_tr_b16 v[232:233], v30 offset:3072
  ds_read_b64_tr_b16 v[234:235], v30 offset:3840
  ds_read_b64_tr_b16 v[236:237], v30 offset:9344
  ds_read_b64_tr_b16 v[238:239], v30 offset:10112
L_sd0:
  buffer_load_dwordx4 v23, s[32:35], s89 offen offset:1024 lds
  s_waitcnt lgkmcnt(0)
  s_bfe_u32 s90, s81, 196616
  s_lshl_b32 s88, s90, 7
  s_add_u32 m0, s83, 16384
  s_add_u32 s88, s88, s76
  buffer_load_dwordx4 v16, s[4:7], s88 offen lds
  v_mfma_f32_16x16x32_bf16 v[240:243], v[224:227], v[208:211], 0
  buffer_load_dwordx4 v17, s[4:7], s88 offen offset:1024 lds
  buffer_load_dwordx4 v18, s[4:7], s88 offen offset:2048 lds
  v_mfma_f32_16x16x32_bf16 v[240:243], v[228:231], v[212:215], v[240:243]
  buffer_load_dwordx4 v19, s[4:7], s88 offen offset:3072 lds
  v_mfma_f32_16x16x32_bf16 v[240:243], v[232:235], v[208:211], v[240:243]
  s_bfe_u32 s90, s81, 196616
  s_add_u32 m0, s84, 33280
  s_mul_i32 s89, s90, s82
  buffer_load_dwordx4 v20, s[8:11], s89 offen lds
  v_mfma_f32_16x16x32_bf16 v[240:243], v[236:239], v[212:215], v[240:243]
  buffer_load_dwordx4 v21, s[8:11], s89 offen offset:1024 lds
  s_xor_b32 s90, s83, 4096
  s_add_u32 m0, s90, 16384
  s_xor_b32 s88, s88, 8192
  buffer_load_dwordx4 v16, s[4:7], s88 offen lds
  buffer_load_dwordx4 v17, s[4:7], s88 offen offset:1024 lds
  s_waitcnt vmcnt(8)
  s_barrier
  buffer_load_dwordx4 v18, s[4:7], s88 offen offset:2048 lds
  buffer_load_dwordx4 v19, s[4:7], s88 offen offset:3072 lds
  s_bfe_u32 s90, s81, 196616
  s_add_u32 m0, s54, 33280
  s_mul_i32 s89, s90, s55
  buffer_load_dwordx4 v22, s[32:35], s89 offen lds
  buffer_load_dwordx4 v23, s[32:35], s89 offen offset:1024 lds
  v_mov_b32 v3, 0
  buffer_load_dword v2, v3, s[16:19], s1 offen sc1
  s_bfe_u32 s90, s81, 196620
  s_lshl_b32 s88, s90, 7
  s_add_u32 m0, s83, 0
  s_add_u32 s88, s88, s76
  buffer_load_dwordx4 v16, s[4:7], s88 offen lds
  buffer_load_dwordx4 v17, s[4:7], s88 offen offset:1024 lds
  s_lshl_b32 s90, s87, 6
  v_add_u32 v6, s90, v4
  v_lshlrev_b32 v6, 10, v6
  v_lshl_add_u32 v12, v7, 4, v6
  v_lshl_add_u32 v13, v8, 4, v6
  v_bfe_u32 v0, v1, 2, 2
  v_lshrrev_b32 v6, 5, v1
  v_lshl_add_u32 v0, v6, 3, v0
  v_lshlrev_b32 v0, 7, v0
  v_and_b32 v6, 3, v1
  v_lshl_add_u32 v0, v6, 3, v0
  buffer_load_dwordx4 v18, s[4:7], s88 offen offset:2048 lds
  v_bfe_u32 v6, v1, 4, 1
  v_lshl_add_u32 v0, v6, 5, v0
  v_bfe_u32 v6, v1, 3, 1
  v_lshl_add_u32 v0, v6, 6, v0
  v_xor_b32 v6, 64, v0
  v_add_u32 v24, s95, v0
  v_add_u32 v25, s95, v6
  v_add_u32 v27, s96, v0
  v_add_u32 v28, s96, v6
  s_lshl_b32 s90, s85, 2
  s_add_u32 s92, s90, s86
  s_and_b32 s91, s77, 1
  s_lshl_b32 s91, s91, 5
  s_and_b32 s90, s77, 2
  s_lshl_b32 s90, s90, 1
  s_add_u32 s91, s90, s91
  s_lshl_b32 s90, s92, 6
  s_add_u32 s72, s90, s91
  v_lshrrev_b32 v0, 5, v1
  v_lshl_add_u32 v26, v0, 4, s72
  v_and_b32 v6, 3, v4
  buffer_load_dwordx4 v19, s[4:7], s88 offen offset:3072 lds
  v_add_u32 v6, v6, v26
  v_lshlrev_b32 v9, 4, v5
  v_lshl_add_u32 v6, v6, 10, v9
  s_lshl_b32 s91, s91, 2
  s_add_u32 s91, s91, s99
  v_lshl_add_u32 v43, v0, 6, s91
  v_bfe_u32 v31, v1, 2, 2
  v_lshl_add_u32 v31, v0, 2, v31
  v_lshlrev_b32 v31, 7, v31
  v_and_b32 v0, 3, v1
  v_lshl_add_u32 v31, v0, 3, v31
  v_and_b32 v0, 16, v1
  v_lshl_add_u32 v31, v0, 1, v31
  s_bfe_u32 s90, s81, 196620
  s_add_u32 m0, s84, 0
  s_mul_i32 s89, s90, s82
  buffer_load_dwordx4 v20, s[8:11], s89 offen lds
  v_add_u32 v31, s99, v31
  s_lshl_b32 s91, s87, 7
  v_and_b32 v9, 31, v1
  v_lshl_add_u32 v9, v9, 1, s91
  v_lshlrev_b32 v0, 1, v9
  v_lshl_add_u32 v26, v26, 11, v0
  s_cmp_eq_u32 s77, 0
  s_cbranch_scc0 L_sb1
  ds_read_b128 v[224:227], v29 offset:16640
  ds_read_b128 v[228:231], v29 offset:18688
  ds_read_b128 v[232:235], v244 offset:16640
  ds_read_b128 v[236:239], v244 offset:18688
  s_branch L_sd1
L_sb1:
  ds_read_b64_tr_b16 v[224:225], v30 offset:16640
  ds_read_b64_tr_b16 v[226:227], v30 offset:17408
  ds_read_b64_tr_b16 v[228:229], v30 offset:22912
  ds_read_b64_tr_b16 v[230:231], v30 offset:23680
  ds_read_b64_tr_b16 v[232:233], v30 offset:19712
  ds_read_b64_tr_b16 v[234:235], v30 offset:20480
  ds_read_b64_tr_b16 v[236:237], v30 offset:25984
  ds_read_b64_tr_b16 v[238:239], v30 offset:26752
L_sd1:
  s_waitcnt lgkmcnt(0)
  v_mfma_f32_16x16x32_bf16 v[240:243], v[224:227], v[208:211], v[240:243]
  v_mfma_f32_16x16x32_bf16 v[240:243], v[228:231], v[212:215], v[240:243]
  v_mfma_f32_16x16x32_bf16 v[240:243], v[232:235], v[208:211], v[240:243]
  v_mfma_f32_16x16x32_bf16 v[240:243], v[236:239], v[212:215], v[240:243]
  buffer_load_dwordx4 v21, s[8:11], s89 offen offset:1024 lds
  s_xor_b32 s90, s83, 4096
  s_add_u32 m0, s90, 0
  s_xor_b32 s88, s88, 8192
  buffer_load_dwordx4 v16, s[4:7], s88 offen lds
  buffer_load_dwordx4 v17, s[4:7], s88 offen offset:1024 lds
  s_waitcnt vmcnt(8)
  v_cmp_gt_u32 vcc, s0, v2
  s_nop 0
  s_cmp_eq_u64 vcc, 0
  s_cbranch_scc0 L_go
L_gook:
  s_waitcnt vmcnt(8) lgkmcnt(0)
  s_barrier
  buffer_load_dwordx4 v18, s[4:7], s88 offen offset:2048 lds
  buffer_load_dwordx4 v19, s[4:7], s88 offen offset:3072 lds
  s_bfe_u32 s90, s81, 196620
  s_add_u32 m0, s54, 0
  s_mul_i32 s89, s90, s55
  buffer_load_dwordx4 v22, s[32:35], s89 offen lds
  buffer_load_dwordx4 v23, s[32:35], s89 offen offset:1024 lds
  s_bfe_u32 s91, s2, 262147
  s_lshl_b32 s91, s91, 7
  s_add_u32 s1, s1, 10551296
  s_add_u32 s91, s91, s1
  s_mul_i32 s0, s0, 16
  v_mov_b32 v2, 1
  s_mov_b64 exec, 1
  buffer_atomic_add v2, v3, s[12:15], s91 offen sc1
  s_mov_b64 exec, -1
  s_bfe_u32 s90, s81, 196624
  s_lshl_b32 s88, s90, 7
  s_add_u32 m0, s83, 8192
  s_add_u32 s88, s88, s76
  buffer_load_dwordx4 v16, s[4:7], s88 offen lds
  buffer_load_dwordx4 v17, s[4:7], s88 offen offset:1024 lds
  v_and_b32 v42, 12, v1
  v_lshlrev_b32 v42, 2, v42
  v_and_or_b32 v42, v1, 3, v42
  v_lshrrev_b32 v0, 4, v1
  buffer_load_dwordx4 v18, s[4:7], s88 offen offset:2048 lds
  v_lshl_add_u32 v42, v0, 2, v42
  v_lshlrev_b32 v42, 4, v42
  v_and_b32 v0, 3, v1
  v_and_b32 v44, 48, v1
  buffer_load_dwordx4 v19, s[4:7], s88 offen offset:3072 lds
  v_lshl_add_u32 v44, v0, 6, v44
  s_lshl_b32 s91, s77, 8
  s_add_u32 s91, s91, 160512
  v_add_u32 v44, s91, v44
  s_cmp_eq_u32 s77, 0
  s_cbranch_scc0 L_sb2
  ds_read_b128 v[224:227], v29 offset:33280
  ds_read_b128 v[228:231], v29 offset:35328
  ds_read_b128 v[232:235], v244 offset:33280
  ds_read_b128 v[236:239], v244 offset:35328
  s_branch L_sd2
L_sb2:
  ds_read_b64_tr_b16 v[224:225], v30 offset:33280
  ds_read_b64_tr_b16 v[226:227], v30 offset:34048
  ds_read_b64_tr_b16 v[228:229], v30 offset:39552
  ds_read_b64_tr_b16 v[230:231], v30 offset:40320
  ds_read_b64_tr_b16 v[232:233], v30 offset:36352
  ds_read_b64_tr_b16 v[234:235], v30 offset:37120
  ds_read_b64_tr_b16 v[236:237], v30 offset:42624
  ds_read_b64_tr_b16 v[238:239], v30 offset:43392
L_sd2:
  s_waitcnt lgkmcnt(0)
  s_bfe_u32 s90, s81, 196624
  s_add_u32 m0, s84, 16640
  s_mul_i32 s89, s90, s82
  buffer_load_dwordx4 v20, s[8:11], s89 offen lds
  v_mfma_f32_16x16x32_bf16 v[240:243], v[224:227], v[208:211], v[240:243]
  v_mfma_f32_16x16x32_bf16 v[240:243], v[228:231], v[212:215], v[240:243]
  v_mfma_f32_16x16x32_bf16 v[240:243], v[232:235], v[208:211], v[240:243]
  v_mfma_f32_16x16x32_bf16 v[240:243], v[236:239], v[212:215], v[240:243]
  buffer_load_dwordx4 v21, s[8:11], s89 offen offset:1024 lds
  s_xor_b32 s90, s83, 4096
  s_add_u32 m0, s90, 8192
  s_xor_b32 s88, s88, 8192
  buffer_load_dwordx4 v16, s[4:7], s88 offen lds
  buffer_load_dwordx4 v17, s[4:7], s88 offen offset:1024 lds
  s_waitcnt vmcnt(9) lgkmcnt(0)
  s_barrier
  buffer_load_dwordx4 v18, s[4:7], s88 offen offset:2048 lds
  buffer_load_dwordx4 v19, s[4:7], s88 offen offset:3072 lds
  s_bfe_u32 s90, s81, 196624
  s_add_u32 m0, s54, 16640
  s_mul_i32 s89, s90, s55
  buffer_load_dwordx4 v22, s[32:35], s89 offen lds
  buffer_load_dwordx4 v23, s[32:35], s89 offen offset:1024 lds
  s_mov_b32 m0, s99
  s_lshl_b32 s91, s87, 7
  buffer_load_dwordx4 v6, s[4:7], s91 offen lds
  s_add_u32 s91, s91, 7168
  buffer_load_dwordx4 v6, s[4:7], s91 offen offset:1024 lds
  s_bfe_u32 s90, s81, 196628
  s_lshl_b32 s88, s90, 7
  s_add_u32 m0, s83, 16384
  s_add_u32 s88, s88, s76
  buffer_load_dwordx4 v16, s[4:7], s88 offen lds
  buffer_load_dwordx4 v17, s[4:7], s88 offen offset:1024 lds
  s_lshr_b32 s91, s2, 7
  s_lshl_b32 s91, s91, 2
  s_add_u32 s91, s91, s86
  s_lshl_b32 s91, s91, 2
  s_lshr_b32 s91, 0x10210210, s91
  s_and_b32 s91, s91, 3
  s_mul_i32 s92, s91, 98304
  s_add_u32 s60, s75, s92
  s_add_u32 s61, s60, 98304
  s_cmp_eq_u32 s91, 2
  s_cselect_b32 s61, s75, s61
  s_add_u32 s64, s61, 98304
  s_cmp_eq_u32 s91, 1
  s_cselect_b32 s64, s75, s64
  s_and_b32 s91, s86, 3
  s_and_b32 s92, s91, 2
  s_lshl_b32 s92, s92, 6
  s_add_u32 s73, s73, s92
  s_xor_b32 s65, s73, 128
  s_bitcmp1_b32 s91, 0
  s_cselect_b32 s91, s24, s20
  s_cselect_b32 s92, s25, s21
  s_cselect_b32 s24, s20, s24
  s_cselect_b32 s25, s21, s25
  s_mov_b32 s20, s91
  s_mov_b32 s21, s92
  s_cmp_eq_u32 s77, 0
  s_cbranch_scc0 L_sb3
  ds_read_b128 v[224:227], v29 offset:0
  ds_read_b128 v[228:231], v29 offset:2048
  ds_read_b128 v[232:235], v244 offset:0
  ds_read_b128 v[236:239], v244 offset:2048
  s_branch L_sd3
L_sb3:
  ds_read_b64_tr_b16 v[224:225], v30 offset:0
  ds_read_b64_tr_b16 v[226:227], v30 offset:768
  ds_read_b64_tr_b16 v[228:229], v30 offset:6272
  ds_read_b64_tr_b16 v[230:231], v30 offset:7040
  ds_read_b64_tr_b16 v[232:233], v30 offset:3072
  ds_read_b64_tr_b16 v[234:235], v30 offset:3840
  ds_read_b64_tr_b16 v[236:237], v30 offset:9344
  ds_read_b64_tr_b16 v[238:239], v30 offset:10112
L_sd3:
  buffer_load_dwordx4 v18, s[4:7], s88 offen offset:2048 lds
  s_waitcnt lgkmcnt(0)
  v_mfma_f32_16x16x32_bf16 v[240:243], v[224:227], v[208:211], v[240:243]
  buffer_load_dwordx4 v19, s[4:7], s88 offen offset:3072 lds
  v_mfma_f32_16x16x32_bf16 v[240:243], v[228:231], v[212:215], v[240:243]
  s_bfe_u32 s90, s81, 196628
  s_add_u32 m0, s84, 33280
  s_mul_i32 s89, s90, s82
  buffer_load_dwordx4 v20, s[8:11], s89 offen lds
  v_mfma_f32_16x16x32_bf16 v[240:243], v[232:235], v[208:211], v[240:243]
  v_mfma_f32_16x16x32_bf16 v[240:243], v[236:239], v[212:215], v[240:243]
  buffer_load_dwordx4 v21, s[8:11], s89 offen offset:1024 lds
  s_xor_b32 s90, s83, 4096
  s_add_u32 m0, s90, 16384
  s_xor_b32 s88, s88, 8192
  buffer_load_dwordx4 v16, s[4:7], s88 offen lds
  buffer_load_dwordx4 v17, s[4:7], s88 offen offset:1024 lds
  s_waitcnt vmcnt(10) lgkmcnt(0)
  s_barrier
  buffer_load_dwordx4 v18, s[4:7], s88 offen offset:2048 lds
  buffer_load_dwordx4 v19, s[4:7], s88 offen offset:3072 lds
  s_bfe_u32 s90, s81, 196628
  s_add_u32 m0, s54, 33280
  s_mul_i32 s89, s90, s55
  buffer_load_dwordx4 v22, s[32:35], s89 offen lds
  buffer_load_dwordx4 v23, s[32:35], s89 offen offset:1024 lds
  s_bfe_u32 s90, s81, 196632
  s_lshl_b32 s88, s90, 7
  s_add_u32 m0, s83, 0
  s_add_u32 s88, s88, s76
  buffer_load_dwordx4 v16, s[4:7], s88 offen lds
  buffer_load_dwordx4 v17, s[4:7], s88 offen offset:1024 lds
  s_cmp_eq_u32 s77, 0
  s_cbranch_scc0 L_sb4
  ds_read_b128 v[224:227], v29 offset:16640
  ds_read_b128 v[228:231], v29 offset:18688
  ds_read_b128 v[232:235], v244 offset:16640
  ds_read_b128 v[236:239], v244 offset:18688
  s_branch L_sd4
L_sb4:
  ds_read_b64_tr_b16 v[224:225], v30 offset:16640
  ds_read_b64_tr_b16 v[226:227], v30 offset:17408
  ds_read_b64_tr_b16 v[228:229], v30 offset:22912
  ds_read_b64_tr_b16 v[230:231], v30 offset:23680
  ds_read_b64_tr_b16 v[232:233], v30 offset:19712
  ds_read_b64_tr_b16 v[234:235], v30 offset:20480
  ds_read_b64_tr_b16 v[236:237], v30 offset:25984
  ds_read_b64_tr_b16 v[238:239], v30 offset:26752
L_sd4:
  buffer_load_dwordx4 v18, s[4:7], s88 offen offset:2048 lds
  s_waitcnt lgkmcnt(0)
  v_mfma_f32_16x16x32_bf16 v[240:243], v[224:227], v[208:211], v[240:243]
  buffer_load_dwordx4 v19, s[4:7], s88 offen offset:3072 lds
  v_mfma_f32_16x16x32_bf16 v[240:243], v[228:231], v[212:215], v[240:243]
  s_bfe_u32 s90, s81, 196632
  s_add_u32 m0, s84, 0
  s_mul_i32 s89, s90, s82
  buffer_load_dwordx4 v20, s[8:11], s89 offen lds
  v_mfma_f32_16x16x32_bf16 v[240:243], v[232:235], v[208:211], v[240:243]
  v_mfma_f32_16x16x32_bf16 v[240:243], v[236:239], v[212:215], v[240:243]
  buffer_load_dwordx4 v21, s[8:11], s89 offen offset:1024 lds
  s_xor_b32 s90, s83, 4096
  s_add_u32 m0, s90, 0
  s_xor_b32 s88, s88, 8192
  buffer_load_dwordx4 v16, s[4:7], s88 offen lds
  buffer_load_dwordx4 v17, s[4:7], s88 offen offset:1024 lds
  s_cmp_eq_u32 s77, 0
  s_cselect_b32 s68, s20, s24
  s_cselect_b32 s69, s21, s25
  s_and_b32 s92, s2, -2
  s_lshl_b32 s91, s92, 11
  s_mul_i32 s92, s92, 5504
  s_cmp_ge_u32 s77, 2
  s_cselect_b32 s68, s28, s68
  s_cselect_b32 s69, s29, s69
  s_cselect_b32 s91, s92, s91
  s_cselect_b32 s92, 42, 31
  v_min_u32 v10, s92, v1
  s_cmp_eq_u32 s77, 3
  s_cselect_b32 s92, 5504, 0
  s_add_u32 s91, s91, s92
  v_lshlrev_b32 v10, 7, v10
  s_bitcmp1_b32 s2, 0
  s_cselect_b32 s91, 0x40000000, s91
  buffer_load_dword v11, v10, s[68:71], s91 offen
  s_mov_b32 s68, s62
  s_mov_b32 s69, s63
  s_waitcnt vmcnt(9) lgkmcnt(0)
  s_barrier
  buffer_load_dwordx4 v18, s[4:7], s88 offen offset:2048 lds
  buffer_load_dwordx4 v19, s[4:7], s88 offen offset:3072 lds
  s_bfe_u32 s90, s81, 196632
  s_add_u32 m0, s54, 0
  s_mul_i32 s89, s90, s55
  buffer_load_dwordx4 v22, s[32:35], s89 offen lds
  buffer_load_dwordx4 v23, s[32:35], s89 offen offset:1024 lds
  v_min_u32 v3, 15, v1
  v_lshlrev_b32 v3, 7, v3
  buffer_load_dword v2, v3, s[12:15], s1 offen sc1
  s_bfe_u32 s90, s81, 196636
  s_lshl_b32 s88, s90, 7
  s_add_u32 m0, s83, 8192
  s_add_u32 s88, s88, s76
  buffer_load_dwordx4 v16, s[4:7], s88 offen lds
  buffer_load_dwordx4 v17, s[4:7], s88 offen offset:1024 lds
  ds_read_b64_tr_b16 v[32:33], v31 offset:0
  ds_read_b64_tr_b16 v[34:35], v31 offset:64
  buffer_load_dwordx4 v18, s[4:7], s88 offen offset:2048 lds
  ds_read_b64_tr_b16 v[36:37], v31 offset:1024
  ds_read_b64_tr_b16 v[38:39], v31 offset:1088
  s_cmp_eq_u32 s77, 0
  s_cbranch_scc0 L_sb5
  ds_read_b128 v[224:227], v29 offset:33280
  ds_read_b128 v[228:231], v29 offset:35328
  ds_read_b128 v[232:235], v244 offset:33280
  ds_read_b128 v[236:239], v244 offset:35328
  s_branch L_sd5
L_sb5:
  ds_read_b64_tr_b16 v[224:225], v30 offset:33280
  ds_read_b64_tr_b16 v[226:227], v30 offset:34048
  ds_read_b64_tr_b16 v[228:229], v30 offset:39552
  ds_read_b64_tr_b16 v[230:231], v30 offset:40320
  ds_read_b64_tr_b16 v[232:233], v30 offset:36352
  ds_read_b64_tr_b16 v[234:235], v30 offset:37120
  ds_read_b64_tr_b16 v[236:237], v30 offset:42624
  ds_read_b64_tr_b16 v[238:239], v30 offset:43392
L_sd5:
  buffer_load_dwordx4 v19, s[4:7], s88 offen offset:3072 lds
  s_waitcnt lgkmcnt(0)
  v_mfma_f32_16x16x32_bf16 v[240:243], v[224:227], v[208:211], v[240:243]
  s_bfe_u32 s90, s81, 196636
  s_add_u32 m0, s84, 16640
  s_mul_i32 s89, s90, s82
  buffer_load_dwordx4 v20, s[8:11], s89 offen lds
  v_mfma_f32_16x16x32_bf16 v[240:243], v[228:231], v[212:215], v[240:243]
  v_mfma_f32_16x16x32_bf16 v[240:243], v[232:235], v[208:211], v[240:243]
  v_mfma_f32_16x16x32_bf16 v[240:243], v[236:239], v[212:215], v[240:243]
  buffer_load_dwordx4 v21, s[8:11], s89 offen offset:1024 lds
  s_xor_b32 s90, s83, 4096
  s_add_u32 m0, s90, 8192
  s_xor_b32 s88, s88, 8192
  buffer_load_dwordx4 v16, s[4:7], s88 offen lds
  buffer_load_dwordx4 v17, s[4:7], s88 offen offset:1024 lds
  s_waitcnt vmcnt(8)
  v_cmp_gt_u32 vcc, s0, v2
  s_nop 0
  s_cmp_eq_u64 vcc, 0
  s_cbranch_scc0 L_poll
L_pollok:
  s_waitcnt vmcnt(8) lgkmcnt(0)
  s_barrier
  buffer_load_dwordx4 v18, s[4:7], s88 offen offset:2048 lds
  buffer_load_dwordx4 v19, s[4:7], s88 offen offset:3072 lds
  s_bfe_u32 s90, s81, 196636
  s_add_u32 m0, s54, 16640
  s_mul_i32 s89, s90, s55
  buffer_load_dwordx4 v22, s[32:35], s89 offen lds
  buffer_load_dwordx4 v23, s[32:35], s89 offen offset:1024 lds
  s_lshl_b32 s91, s94, 10
  s_add_u32 s91, s91, 10485760
  s_mov_b32 m0, s99
  s_lshl_b32 s92, s94, 9
  buffer_load_dwordx4 v42, s[12:15], s91 offen sc1 lds
  s_lshr_b32 s91, s72, 6
  s_lshl_b32 s91, s91, 9
  s_add_u32 s91, s91, 10517504
  s_mov_b32 exec_hi, 0
  buffer_load_dwordx4 v15, s[12:15], s91 offen offset:1024 sc1 lds
  s_lshl_b32 s91, s77, 9
  s_add_u32 m0, s91, 161536
  s_add_u32 s92, s92, 10518528
  buffer_load_dwordx4 v15, s[12:15], s92 offen sc1 lds
  s_mov_b64 exec, -1
  s_add_u32 m0, s95, 16384
  s_add_u32 s90, s60, 0
  buffer_load_dwordx4 v14, s[28:31], s90 offen lds
  s_add_u32 s90, s60, 7168
  buffer_load_dwordx4 v14, s[28:31], s90 offen offset:1024 lds
  s_cmp_eq_u32 s77, 0
  s_cbranch_scc0 L_sb6
  ds_read_b128 v[224:227], v29 offset:0
  ds_read_b128 v[228:231], v29 offset:2048
  ds_read_b128 v[232:235], v244 offset:0
  ds_read_b128 v[236:239], v244 offset:2048
  s_branch L_sd6
L_sb6:
  ds_read_b64_tr_b16 v[224:225], v30 offset:0
  ds_read_b64_tr_b16 v[226:227], v30 offset:768
  ds_read_b64_tr_b16 v[228:229], v30 offset:6272
  ds_read_b64_tr_b16 v[230:231], v30 offset:7040
  ds_read_b64_tr_b16 v[232:233], v30 offset:3072
  ds_read_b64_tr_b16 v[234:235], v30 offset:3840
  ds_read_b64_tr_b16 v[236:237], v30 offset:9344
  ds_read_b64_tr_b16 v[238:239], v30 offset:10112
L_sd6:
  s_add_u32 s90, s60, 14336
  buffer_load_dwordx4 v14, s[28:31], s90 offen offset:2048 lds
  s_waitcnt lgkmcnt(0)
  v_mfma_f32_16x16x32_bf16 v[240:243], v[224:227], v[208:211], v[240:243]
  s_add_u32 s90, s60, 21504
  buffer_load_dwordx4 v14, s[28:31], s90 offen offset:3072 lds
  v_mfma_f32_16x16x32_bf16 v[240:243], v[228:231], v[212:215], v[240:243]
  s_add_u32 m0, s95, 20480
  s_add_u32 s90, s60, 32768
  buffer_load_dwordx4 v14, s[28:31], s90 offen lds
  v_mfma_f32_16x16x32_bf16 v[240:243], v[232:235], v[208:211], v[240:243]
  v_mfma_f32_16x16x32_bf16 v[240:243], v[236:239], v[212:215], v[240:243]
  s_add_u32 s90, s60, 39936
  buffer_load_dwordx4 v14, s[28:31], s90 offen offset:1024 lds
  s_add_u32 s90, s60, 47104
  buffer_load_dwordx4 v14, s[28:31], s90 offen offset:2048 lds
  s_add_u32 s90, s60, 54272
  buffer_load_dwordx4 v14, s[28:31], s90 offen offset:3072 lds
  s_waitcnt vmcnt(8) lgkmcnt(0)
  s_barrier
  s_add_u32 m0, s96, 33280
  s_add_u32 s90, s60, 65536
  buffer_load_dwordx4 v14, s[28:31], s90 offen lds
  s_add_u32 s90, s60, 72704
  buffer_load_dwordx4 v14, s[28:31], s90 offen offset:1024 lds
  ds_read_b128 v[192:195], v43 offset:1024
  ds_read_b128 v[196:199], v43 offset:1280
  ds_read_b128 v[200:203], v43 offset:1056
  ds_read_b128 v[204:207], v43 offset:1312
  s_cmp_eq_u32 s77, 0
  s_cbranch_scc0 L_sb7
  ds_read_b128 v[224:227], v29 offset:16640
  ds_read_b128 v[228:231], v29 offset:18688
  ds_read_b128 v[232:235], v244 offset:16640
  ds_read_b128 v[236:239], v244 offset:18688
  s_branch L_sd7
L_sb7:
  ds_read_b64_tr_b16 v[224:225], v30 offset:16640
  ds_read_b64_tr_b16 v[226:227], v30 offset:17408
  ds_read_b64_tr_b16 v[228:229], v30 offset:22912
  ds_read_b64_tr_b16 v[230:231], v30 offset:23680
  ds_read_b64_tr_b16 v[232:233], v30 offset:19712
  ds_read_b64_tr_b16 v[234:235], v30 offset:20480
  ds_read_b64_tr_b16 v[236:237], v30 offset:25984
  ds_read_b64_tr_b16 v[238:239], v30 offset:26752
L_sd7:
  s_waitcnt lgkmcnt(0)
  v_mfma_f32_16x16x32_bf16 v[240:243], v[224:227], v[208:211], v[240:243]
  v_mfma_f32_16x16x32_bf16 v[240:243], v[228:231], v[212:215], v[240:243]
  v_mfma_f32_16x16x32_bf16 v[240:243], v[232:235], v[208:211], v[240:243]
  v_mfma_f32_16x16x32_bf16 v[240:243], v[236:239], v[212:215], v[240:243]
  v_lshlrev_b32 v40, 16, v40
  v_lshlrev_b32 v41, 16, v41
  v_lshlrev_b32 v48, 16, v32
  v_fma_f32 v0, v48, v192, v196
  v_fmac_f32 v48, v0, v40
  v_and_b32 v49, 0xffff0000, v32
  v_fma_f32 v0, v49, v193, v197
  v_fmac_f32 v49, v0, v40
  v_lshlrev_b32 v50, 16, v33
  v_fma_f32 v0, v50, v194, v198
  v_fmac_f32 v50, v0, v40
  v_and_b32 v51, 0xffff0000, v33
  v_fma_f32 v0, v51, v195, v199
  v_fmac_f32 v51, v0, v40
  v_lshlrev_b32 v64, 16, v34
  v_fma_f32 v0, v64, v192, v196
  v_fmac_f32 v64, v0, v41
  v_and_b32 v65, 0xffff0000, v34
  v_fma_f32 v0, v65, v193, v197
  v_fmac_f32 v65, v0, v41
  v_lshlrev_b32 v66, 16, v35
  v_fma_f32 v0, v66, v194, v198
  v_fmac_f32 v66, v0, v41
  v_and_b32 v67, 0xffff0000, v35
  v_fma_f32 v0, v67, v195, v199
  v_fmac_f32 v67, v0, v41
  v_lshlrev_b32 v80, 16, v36
  v_fma_f32 v0, v80, v200, v204
  v_fmac_f32 v80, v0, v40
  v_and_b32 v81, 0xffff0000, v36
  v_fma_f32 v0, v81, v201, v205
  v_fmac_f32 v81, v0, v40
  v_lshlrev_b32 v82, 16, v37
  v_fma_f32 v0, v82, v202, v206
  v_fmac_f32 v82, v0, v40
  v_and_b32 v83, 0xffff0000, v37
  v_fma_f32 v0, v83, v203, v207
  v_fmac_f32 v83, v0, v40
  v_lshlrev_b32 v96, 16, v38
  v_fma_f32 v0, v96, v200, v204
  v_fmac_f32 v96, v0, v41
  v_and_b32 v97, 0xffff0000, v38
  v_fma_f32 v0, v97, v201, v205
  v_fmac_f32 v97, v0, v41
  v_lshlrev_b32 v98, 16, v39
  v_fma_f32 v0, v98, v202, v206
  v_fmac_f32 v98, v0, v41
  v_and_b32 v99, 0xffff0000, v39
  v_fma_f32 v0, v99, v203, v207
  v_fmac_f32 v99, v0, v41
  s_waitcnt vmcnt(0)
  s_mov_b32 exec_lo, 0x000f000f
  s_mov_b32 exec_hi, 0x000f000f
  ds_write_b128 v44, v[240:243]
  s_mov_b64 exec, -1
  s_add_u32 s90, s60, 79872
  buffer_load_dwordx4 v14, s[28:31], s90 offen offset:2048 lds
  s_add_u32 s90, s60, 87040
  buffer_load_dwordx4 v14, s[28:31], s90 offen offset:3072 lds
  s_add_u32 m0, s95, 0
  s_add_u32 s90, s61, 0
  buffer_load_dwordx4 v14, s[28:31], s90 offen lds
  s_add_u32 s90, s61, 7168
  buffer_load_dwordx4 v14, s[28:31], s90 offen offset:1024 lds
  s_add_u32 s90, s61, 14336
  buffer_load_dwordx4 v14, s[28:31], s90 offen offset:2048 lds
  s_add_u32 s90, s61, 21504
  buffer_load_dwordx4 v14, s[28:31], s90 offen offset:3072 lds
  s_add_u32 m0, s95, 4096
  s_add_u32 s90, s61, 32768
  buffer_load_dwordx4 v14, s[28:31], s90 offen lds
  s_add_u32 s90, s61, 39936
  buffer_load_dwordx4 v14, s[28:31], s90 offen offset:1024 lds
  s_add_u32 s90, s61, 47104
  buffer_load_dwordx4 v14, s[28:31], s90 offen offset:2048 lds
  s_add_u32 s90, s61, 54272
  buffer_load_dwordx4 v14, s[28:31], s90 offen offset:3072 lds
  s_waitcnt lgkmcnt(0)
  s_setprio 0
  s_barrier
  s_add_u32 m0, s96, 0
  s_add_u32 s90, s61, 65536
  buffer_load_dwordx4 v14, s[28:31], s90 offen lds
  s_add_u32 s90, s61, 72704
  buffer_load_dwordx4 v14, s[28:31], s90 offen offset:1024 lds
  s_add_u32 s90, s61, 79872
  buffer_load_dwordx4 v14, s[28:31], s90 offen offset:2048 lds
  s_add_u32 s90, s61, 87040
  buffer_load_dwordx4 v14, s[28:31], s90 offen offset:3072 lds
  s_waitcnt vmcnt(12)
  ds_read_b64_tr_b16 v[112:113], v24 offset:16384
  ds_read_b64_tr_b16 v[114:115], v24 offset:16896
  s_add_u32 m0, s95, 8192
  s_add_u32 s90, s64, 0
  buffer_load_dwordx4 v14, s[28:31], s90 offen lds
  ds_read_b64_tr_b16 v[116:117], v25 offset:16384
  ds_read_b64_tr_b16 v[118:119], v25 offset:16896
  s_add_u32 s90, s64, 7168
  buffer_load_dwordx4 v14, s[28:31], s90 offen offset:1024 lds
  ds_read_b64_tr_b16 v[120:121], v24 offset:18432
  ds_read_b64_tr_b16 v[122:123], v24 offset:18944
  s_add_u32 s90, s64, 14336
  buffer_load_dwordx4 v14, s[28:31], s90 offen offset:2048 lds
  ds_read_b64_tr_b16 v[124:125], v25 offset:18432
  ds_read_b64_tr_b16 v[126:127], v25 offset:18944
  s_add_u32 s90, s64, 21504
  buffer_load_dwordx4 v14, s[28:31], s90 offen offset:3072 lds
  ds_read_b64_tr_b16 v[128:129], v24 offset:20480
  ds_read_b64_tr_b16 v[130:131], v24 offset:20992
  s_add_u32 m0, s95, 12288
  s_add_u32 s90, s64, 32768
  buffer_load_dwordx4 v14, s[28:31], s90 offen lds
  ds_read_b64_tr_b16 v[132:133], v25 offset:20480
  ds_read_b64_tr_b16 v[134:135], v25 offset:20992
  s_add_u32 s90, s64, 39936
  buffer_load_dwordx4 v14, s[28:31], s90 offen offset:1024 lds
  ds_read_b64_tr_b16 v[136:137], v24 offset:22528
  ds_read_b64_tr_b16 v[138:139], v24 offset:23040
  s_add_u32 s90, s64, 47104
  buffer_load_dwordx4 v14, s[28:31], s90 offen offset:2048 lds
  ds_read_b64_tr_b16 v[140:141], v25 offset:22528
  ds_read_b64_tr_b16 v[142:143], v25 offset:23040
  s_add_u32 s90, s64, 54272
  buffer_load_dwordx4 v14, s[28:31], s90 offen offset:3072 lds
  ds_read_b64_tr_b16 v[144:145], v27 offset:33280
  ds_read_b64_tr_b16 v[146:147], v27 offset:33792
  s_add_u32 m0, s96, 16640
  s_add_u32 s90, s64, 65536
  buffer_load_dwordx4 v14, s[28:31], s90 offen lds
  ds_read_b64_tr_b16 v[148:149], v28 offset:33280
  ds_read_b64_tr_b16 v[150:151], v28 offset:33792
  s_add_u32 s90, s64, 72704
  buffer_load_dwordx4 v14, s[28:31], s90 offen offset:1024 lds
  ds_read_b64_tr_b16 v[152:153], v27 offset:35328
  ds_read_b64_tr_b16 v[154:155], v27 offset:35840
  s_add_u32 s90, s64, 79872
  buffer_load_dwordx4 v14, s[28:31], s90 offen offset:2048 lds
  ds_read_b64_tr_b16 v[156:157], v28 offset:35328
  ds_read_b64_tr_b16 v[158:159], v28 offset:35840
  s_add_u32 s90, s64, 87040
  buffer_load_dwordx4 v14, s[28:31], s90 offen offset:3072 lds
  s_waitcnt vmcnt(12) lgkmcnt(0)
  ds_read_b64_tr_b16 v[160:161], v24 offset:0
  ds_read_b64_tr_b16 v[162:163], v24 offset:512
  s_add_u32 m0, s95, 16384
  s_add_u32 s90, s73, 0
  s_waitcnt vmcnt(8)
  buffer_load_dwordx4 v12, s[20:23], s90 offen lds
  ds_read_b64_tr_b16 v[164:165], v25 offset:0
  ds_read_b64_tr_b16 v[166:167], v25 offset:512
  s_add_u32 s90, s73, 7168
  s_waitcnt vmcnt(8)
  buffer_load_dwordx4 v13, s[20:23], s90 offen offset:1024 lds
  ds_read_b64_tr_b16 v[168:169], v24 offset:2048
  ds_read_b64_tr_b16 v[170:171], v24 offset:2560
  s_add_u32 s90, s73, 14336
  s_waitcnt vmcnt(8)
  buffer_load_dwordx4 v12, s[20:23], s90 offen offset:2048 lds
  ds_read_b64_tr_b16 v[172:173], v25 offset:2048
  ds_read_b64_tr_b16 v[174:175], v25 offset:2560
  s_add_u32 s90, s73, 21504
  s_waitcnt vmcnt(8)
  buffer_load_dwordx4 v13, s[20:23], s90 offen offset:3072 lds
  ds_read_b64_tr_b16 v[176:177], v24 offset:4096
  ds_read_b64_tr_b16 v[178:179], v24 offset:4608
  s_add_u32 m0, s95, 20480
  s_add_u32 s90, s73, 32768
  s_waitcnt vmcnt(8)
  buffer_load_dwordx4 v12, s[20:23], s90 offen lds
  ds_read_b64_tr_b16 v[180:181], v25 offset:4096
  ds_read_b64_tr_b16 v[182:183], v25 offset:4608
  s_add_u32 s90, s73, 39936
  s_waitcnt vmcnt(8)
  buffer_load_dwordx4 v13, s[20:23], s90 offen offset:1024 lds
  ds_read_b64_tr_b16 v[184:185], v24 offset:6144
  ds_read_b64_tr_b16 v[186:187], v24 offset:6656
  s_add_u32 s90, s73, 47104
  s_waitcnt vmcnt(8)
  buffer_load_dwordx4 v12, s[20:23], s90 offen offset:2048 lds
  ds_read_b64_tr_b16 v[188:189], v25 offset:6144
  ds_read_b64_tr_b16 v[190:191], v25 offset:6656
  s_add_u32 s90, s73, 54272
  s_waitcnt vmcnt(8)
  buffer_load_dwordx4 v13, s[20:23], s90 offen offset:3072 lds
  ds_read_b64_tr_b16 v[192:193], v27 offset:0
  ds_read_b64_tr_b16 v[194:195], v27 offset:512
  s_add_u32 m0, s96, 33280
  s_add_u32 s90, s75, 294912
  s_waitcnt vmcnt(8)
  buffer_load_dwordx4 v14, s[28:31], s90 offen lds
  ds_read_b64_tr_b16 v[196:197], v28 offset:0
  ds_read_b64_tr_b16 v[198:199], v28 offset:512
  s_add_u32 s90, s75, 302080
  s_waitcnt vmcnt(8)
  buffer_load_dwordx4 v14, s[28:31], s90 offen offset:1024 lds
  ds_read_b64_tr_b16 v[200:201], v27 offset:2048
  ds_read_b64_tr_b16 v[202:203], v27 offset:2560
  s_add_u32 s90, s75, 309248
  s_waitcnt vmcnt(8)
  buffer_load_dwordx4 v14, s[28:31], s90 offen offset:2048 lds
  ds_read_b64_tr_b16 v[204:205], v28 offset:2048
  ds_read_b64_tr_b16 v[206:207], v28 offset:2560
  s_add_u32 s90, s75, 316416
  s_waitcnt vmcnt(8)
  buffer_load_dwordx4 v14, s[28:31], s90 offen offset:3072 lds
  s_waitcnt vmcnt(12) lgkmcnt(0)
  ds_read_b64_tr_b16 v[208:209], v24 offset:8192
  ds_read_b64_tr_b16 v[210:211], v24 offset:8704
  s_add_u32 m0, s95, 0
  s_add_u32 s90, s73, 0
  s_waitcnt vmcnt(8)
  buffer_load_dwordx4 v12, s[24:27], s90 offen lds
  ds_read_b64_tr_b16 v[212:213], v25 offset:8192
  ds_read_b64_tr_b16 v[214:215], v25 offset:8704
  s_add_u32 s90, s73, 7168
  s_waitcnt vmcnt(8)
  buffer_load_dwordx4 v13, s[24:27], s90 offen offset:1024 lds
  ds_read_b64_tr_b16 v[216:217], v24 offset:10240
  ds_read_b64_tr_b16 v[218:219], v24 offset:10752
  s_add_u32 s90, s73, 14336
  s_waitcnt vmcnt(8)
  buffer_load_dwordx4 v12, s[24:27], s90 offen offset:2048 lds
  ds_read_b64_tr_b16 v[220:221], v25 offset:10240
  ds_read_b64_tr_b16 v[222:223], v25 offset:10752
  s_add_u32 s90, s73, 21504
  s_waitcnt vmcnt(8)
  buffer_load_dwordx4 v13, s[24:27], s90 offen offset:3072 lds
  ds_read_b64_tr_b16 v[224:225], v24 offset:12288
  ds_read_b64_tr_b16 v[226:227], v24 offset:12800
  s_add_u32 m0, s95, 4096
  s_add_u32 s90, s73, 32768
  s_waitcnt vmcnt(8)
  buffer_load_dwordx4 v12, s[24:27], s90 offen lds
  ds_read_b64_tr_b16 v[228:229], v25 offset:12288
  ds_read_b64_tr_b16 v[230:231], v25 offset:12800
  s_add_u32 s90, s73, 39936
  s_waitcnt vmcnt(8)
  buffer_load_dwordx4 v13, s[24:27], s90 offen offset:1024 lds
  ds_read_b64_tr_b16 v[232:233], v24 offset:14336
  ds_read_b64_tr_b16 v[234:235], v24 offset:14848
  s_add_u32 s90, s73, 47104
  s_waitcnt vmcnt(8)
  buffer_load_dwordx4 v12, s[24:27], s90 offen offset:2048 lds
  ds_read_b64_tr_b16 v[236:237], v25 offset:14336
  ds_read_b64_tr_b16 v[238:239], v25 offset:14848
  s_add_u32 s90, s73, 54272
  s_waitcnt vmcnt(8)
  buffer_load_dwordx4 v13, s[24:27], s90 offen offset:3072 lds
  ds_read_b64_tr_b16 v[240:241], v27 offset:16640
  ds_read_b64_tr_b16 v[242:243], v27 offset:17152
  s_add_u32 m0, s96, 0
  s_add_u32 s90, s65, 0
  s_waitcnt vmcnt(8)
  buffer_load_dwordx4 v12, s[24:27], s90 offen lds
  ds_read_b64_tr_b16 v[244:245], v28 offset:16640
  ds_read_b64_tr_b16 v[246:247], v28 offset:17152
  s_add_u32 s90, s65, 7168
  s_waitcnt vmcnt(8)
  buffer_load_dwordx4 v13, s[24:27], s90 offen offset:1024 lds
  ds_read_b64_tr_b16 v[248:249], v27 offset:18688
  ds_read_b64_tr_b16 v[250:251], v27 offset:19200
  s_add_u32 s90, s65, 14336
  s_waitcnt vmcnt(8)
  buffer_load_dwordx4 v12, s[24:27], s90 offen offset:2048 lds
  ds_read_b64_tr_b16 v[252:253], v28 offset:18688
  ds_read_b64_tr_b16 v[254:255], v28 offset:19200
  s_add_u32 s90, s65, 21504
  s_waitcnt vmcnt(8)
  buffer_load_dwordx4 v13, s[24:27], s90 offen offset:3072 lds
  s_lshl_b32 s90, s85, 2
  s_add_u32 s90, s90, s86
  s_mul_i32 s88, s90, 307200
  s_lshl_b32 s94, s90, 2
  s_add_u32 s94, s94, s77
  s_lshl_b32 s94, s94, 8
  s_add_u32 s94, s94, 10616832
  s_lshl_b32 s90, s93, 10
  s_add_u32 s89, s88, s90
  s_lshr_b32 s60, s60, 4
  s_add_u32 s60, s60, s88
  s_lshr_b32 s61, s61, 4
  s_add_u32 s61, s61, s88
  s_lshr_b32 s64, s64, 4
  s_add_u32 s64, s64, s88
  s_lshl_b32 s91, s77, 7
  v_xor_b32 v11, s91, v15
  v_mov_b32 v10, v26
  s_lshl_b32 s91, s77, 2
  s_add_u32 s91, s91, 163584
  v_mov_b32 v2, s91
  v_mov_b32 v3, 1
  s_waitcnt lgkmcnt(0)
  s_add_u32 m0, s95, 8192
  s_add_u32 s90, s65, 0
  s_waitcnt vmcnt(8)
  buffer_load_dwordx4 v12, s[20:23], s90 offen lds
  s_add_u32 s90, s65, 7168
  s_waitcnt vmcnt(8)
  buffer_load_dwordx4 v13, s[20:23], s90 offen offset:1024 lds
  s_add_u32 s90, s65, 14336
  s_waitcnt vmcnt(8)
  buffer_load_dwordx4 v12, s[20:23], s90 offen offset:2048 lds
  s_add_u32 s90, s65, 21504
  s_waitcnt vmcnt(8)
  buffer_load_dwordx4 v13, s[20:23], s90 offen offset:3072 lds
  s_add_u32 m0, s95, 12288
  s_add_u32 s90, s65, 32768
  s_waitcnt vmcnt(8)
  buffer_load_dwordx4 v12, s[20:23], s90 offen lds
  s_add_u32 s90, s65, 39936
  s_waitcnt vmcnt(8)
  buffer_load_dwordx4 v13, s[20:23], s90 offen offset:1024 lds
  s_add_u32 s90, s65, 47104
  s_waitcnt vmcnt(8)
  buffer_load_dwordx4 v12, s[20:23], s90 offen offset:2048 lds
  s_add_u32 s90, s65, 54272
  s_waitcnt vmcnt(8)
  buffer_load_dwordx4 v13, s[20:23], s90 offen offset:3072 lds
  s_load_dword s55, s[66:67], s94 glc
  s_add_u32 m0, s96, 16640
  s_add_u32 s90, s65, 32768
  s_waitcnt vmcnt(8)
  buffer_load_dwordx4 v12, s[24:27], s90 offen lds
  s_add_u32 s90, s65, 39936
  s_waitcnt vmcnt(8)
  buffer_load_dwordx4 v13, s[24:27], s90 offen offset:1024 lds
  s_add_u32 s90, s65, 47104
  s_waitcnt vmcnt(8)
  buffer_load_dwordx4 v12, s[24:27], s90 offen offset:2048 lds
  s_add_u32 s90, s65, 54272
  s_waitcnt vmcnt(8)
  buffer_load_dwordx4 v13, s[24:27], s90 offen offset:3072 lds
  s_waitcnt lgkmcnt(0)
  s_cmp_lt_u32 s55, 6
  s_cbranch_scc1 L_fp1
L_fp1_ok:
  s_setprio 1
  s_add_u32 s90, s60, 0
  buffer_load_dwordx4 v[16:19], v11, s[12:15], s90 offen sc1
  s_add_u32 s90, s60, 153600
  buffer_load_dwordx4 v[20:23], v11, s[12:15], s90 offen sc1
  s_add_u32 s90, s60, 1024
  buffer_load_dwordx4 v[24:27], v11, s[12:15], s90 offen sc1
  s_add_u32 s90, s60, 154624
  buffer_load_dwordx4 v[28:31], v11, s[12:15], s90 offen sc1
  s_add_u32 s90, s60, 2048
  buffer_load_dwordx4 v[32:35], v11, s[12:15], s90 offen sc1
  s_add_u32 s90, s60, 155648
  buffer_load_dwordx4 v[36:39], v11, s[12:15], s90 offen sc1
  s_add_u32 s90, s60, 3072
  buffer_load_dwordx4 v[40:43], v11, s[12:15], s90 offen sc1
  s_add_u32 s90, s60, 156672
  buffer_load_dwordx4 v[44:47], v11, s[12:15], s90 offen sc1
  s_add_u32 s90, s60, 4096
  buffer_load_dwordx4 v[4:7], v11, s[12:15], s90 offen sc1
  s_waitcnt vmcnt(9)
  ds_write_b32 v2, v3
  s_waitcnt vmcnt(8)
  v_mfma_f32_32x32x16_bf16 v[48:63], v[16:19], v[112:115], v[48:63]
  v_mfma_f32_32x32x16_bf16 v[64:79], v[16:19], v[116:119], v[64:79]
  s_add_u32 s90, s60, 157696
  buffer_load_dwordx4 v[16:19], v11, s[12:15], s90 offen sc1
  s_waitcnt vmcnt(8)
  v_mfma_f32_32x32x16_bf16 v[80:95], v[20:23], v[112:115], v[80:95]
  v_mfma_f32_32x32x16_bf16 v[96:111], v[20:23], v[116:119], v[96:111]
  s_add_u32 s90, s60, 5120
  buffer_load_dwordx4 v[20:23], v11, s[12:15], s90 offen sc1
  s_waitcnt vmcnt(8)
  v_mfma_f32_32x32x16_bf16 v[48:63], v[24:27], v[120:123], v[48:63]
  s_add_u32 s90, s60, 158720
  buffer_load_dwordx4 v[112:115], v11, s[12:15], s90 offen sc1
  v_mfma_f32_32x32x16_bf16 v[64:79], v[24:27], v[124:127], v[64:79]
  s_add_u32 s90, s61, 0
  buffer_load_dwordx4 v[116:119], v11, s[12:15], s90 offen sc1
  s_waitcnt vmcnt(9)
  v_mfma_f32_32x32x16_bf16 v[80:95], v[28:31], v[120:123], v[80:95]
  v_mfma_f32_32x32x16_bf16 v[96:111], v[28:31], v[124:127], v[96:111]
  s_add_u32 s90, s61, 153600
  buffer_load_dwordx4 v[24:27], v11, s[12:15], s90 offen sc1
  s_waitcnt vmcnt(9)
  v_mfma_f32_32x32x16_bf16 v[48:63], v[32:35], v[128:131], v[48:63]
  s_add_u32 s90, s61, 1024
  buffer_load_dwordx4 v[28:31], v11, s[12:15], s90 offen sc1
  v_mfma_f32_32x32x16_bf16 v[64:79], v[32:35], v[132:135], v[64:79]
  s_add_u32 s90, s61, 154624
  buffer_load_dwordx4 v[120:123], v11, s[12:15], s90 offen sc1
  s_waitcnt vmcnt(10)
  v_mfma_f32_32x32x16_bf16 v[80:95], v[36:39], v[128:131], v[80:95]
  v_mfma_f32_32x32x16_bf16 v[96:111], v[36:39], v[132:135], v[96:111]
  s_add_u32 s90, s61, 2048
  buffer_load_dwordx4 v[124:127], v11, s[12:15], s90 offen sc1
  s_waitcnt vmcnt(10)
  v_mfma_f32_32x32x16_bf16 v[48:63], v[40:43], v[136:139], v[48:63]
  s_add_u32 s90, s61, 155648
  buffer_load_dwordx4 v[32:35], v11, s[12:15], s90 offen sc1
  v_mfma_f32_32x32x16_bf16 v[64:79], v[40:43], v[140:143], v[64:79]
  s_add_u32 s90, s61, 3072
  buffer_load_dwordx4 v[36:39], v11, s[12:15], s90 offen sc1
  s_waitcnt vmcnt(11)
  v_mfma_f32_32x32x16_bf16 v[80:95], v[44:47], v[136:139], v[80:95]
  v_mfma_f32_32x32x16_bf16 v[96:111], v[44:47], v[140:143], v[96:111]
  s_add_u32 s90, s61, 156672
  buffer_load_dwordx4 v[128:131], v11, s[12:15], s90 offen sc1
  s_waitcnt vmcnt(11)
  v_mfma_f32_32x32x16_bf16 v[48:63], v[4:7], v[144:147], v[48:63]
  v_mfma_f32_32x32x16_bf16 v[64:79], v[4:7], v[148:151], v[64:79]
  s_add_u32 s90, s61, 4096
  buffer_load_dwordx4 v[132:135], v11, s[12:15], s90 offen sc1
  s_waitcnt vmcnt(11)
  v_mfma_f32_32x32x16_bf16 v[80:95], v[16:19], v[144:147], v[80:95]
  v_mfma_f32_32x32x16_bf16 v[96:111], v[16:19], v[148:151], v[96:111]
  s_add_u32 s90, s61, 157696
  buffer_load_dwordx4 v[40:43], v11, s[12:15], s90 offen sc1
  s_waitcnt vmcnt(11)
  v_mfma_f32_32x32x16_bf16 v[48:63], v[20:23], v[152:155], v[48:63]
  v_mfma_f32_32x32x16_bf16 v[64:79], v[20:23], v[156:159], v[64:79]
  s_add_u32 s90, s61, 5120
  buffer_load_dwordx4 v[44:47], v11, s[12:15], s90 offen sc1
  s_waitcnt vmcnt(11)
  v_mfma_f32_32x32x16_bf16 v[80:95], v[112:115], v[152:155], v[80:95]
  v_mfma_f32_32x32x16_bf16 v[96:111], v[112:115], v[156:159], v[96:111]
  s_add_u32 s90, s61, 158720
  buffer_load_dwordx4 v[136:139], v11, s[12:15], s90 offen sc1
  s_waitcnt vmcnt(11)
  v_mfma_f32_32x32x16_bf16 v[48:63], v[116:119], v[160:163], v[48:63]
  v_mfma_f32_32x32x16_bf16 v[64:79], v[116:119], v[164:167], v[64:79]
  s_add_u32 s90, s64, 0
  buffer_load_dwordx4 v[140:143], v11, s[12:15], s90 offen sc1
  s_waitcnt vmcnt(11)
  v_mfma_f32_32x32x16_bf16 v[80:95], v[24:27], v[160:163], v[80:95]
  v_mfma_f32_32x32x16_bf16 v[96:111], v[24:27], v[164:167], v[96:111]
  s_add_u32 s90, s64, 153600
  buffer_load_dwordx4 v[4:7], v11, s[12:15], s90 offen sc1
  s_waitcnt vmcnt(11)
  v_mfma_f32_32x32x16_bf16 v[48:63], v[28:31], v[168:171], v[48:63]
  v_mfma_f32_32x32x16_bf16 v[64:79], v[28:31], v[172:175], v[64:79]
  s_add_u32 s90, s64, 1024
  buffer_load_dwordx4 v[16:19], v11, s[12:15], s90 offen sc1
  s_waitcnt vmcnt(11)
  v_mfma_f32_32x32x16_bf16 v[80:95], v[120:123], v[168:171], v[80:95]
  v_mfma_f32_32x32x16_bf16 v[96:111], v[120:123], v[172:175], v[96:111]
  s_add_u32 s90, s64, 154624
  buffer_load_dwordx4 v[144:147], v11, s[12:15], s90 offen sc1
  s_waitcnt vmcnt(11)
  v_mfma_f32_32x32x16_bf16 v[48:63], v[124:127], v[176:179], v[48:63]
  v_mfma_f32_32x32x16_bf16 v[64:79], v[124:127], v[180:183], v[64:79]
  s_add_u32 s90, s64, 2048
  buffer_load_dwordx4 v[148:151], v11, s[12:15], s90 offen sc1
  s_waitcnt vmcnt(11)
  v_mfma_f32_32x32x16_bf16 v[80:95], v[32:35], v[176:179], v[80:95]
  v_mfma_f32_32x32x16_bf16 v[96:111], v[32:35], v[180:183], v[96:111]
  s_add_u32 s90, s64, 155648
  buffer_load_dwordx4 v[20:23], v11, s[12:15], s90 offen sc1
  s_barrier
  s_waitcnt vmcnt(11)
  v_mfma_f32_32x32x16_bf16 v[48:63], v[36:39], v[184:187], v[48:63]
  v_mfma_f32_32x32x16_bf16 v[64:79], v[36:39], v[188:191], v[64:79]
  s_add_u32 s90, s64, 3072
  buffer_load_dwordx4 v[112:115], v11, s[12:15], s90 offen sc1
  s_waitcnt vmcnt(11)
  v_mfma_f32_32x32x16_bf16 v[80:95], v[128:131], v[184:187], v[80:95]
  v_mfma_f32_32x32x16_bf16 v[96:111], v[128:131], v[188:191], v[96:111]
  s_add_u32 s90, s64, 156672
  buffer_load_dwordx4 v[152:155], v11, s[12:15], s90 offen sc1
  s_waitcnt vmcnt(11)
  v_mfma_f32_32x32x16_bf16 v[48:63], v[132:135], v[192:195], v[48:63]
  v_mfma_f32_32x32x16_bf16 v[64:79], v[132:135], v[196:199], v[64:79]
  s_add_u32 s90, s64, 4096
  buffer_load_dwordx4 v[156:159], v11, s[12:15], s90 offen sc1
  s_waitcnt vmcnt(11)
  v_mfma_f32_32x32x16_bf16 v[80:95], v[40:43], v[192:195], v[80:95]
  v_mfma_f32_32x32x16_bf16 v[96:111], v[40:43], v[196:199], v[96:111]
  s_add_u32 s90, s64, 157696
  buffer_load_dwordx4 v[116:119], v11, s[12:15], s90 offen sc1
  s_waitcnt vmcnt(11)
  v_mfma_f32_32x32x16_bf16 v[48:63], v[44:47], v[200:203], v[48:63]
  v_mfma_f32_32x32x16_bf16 v[64:79], v[44:47], v[204:207], v[64:79]
  s_add_u32 s90, s64, 5120
  buffer_load_dwordx4 v[24:27], v11, s[12:15], s90 offen sc1
  s_waitcnt vmcnt(11)
  v_mfma_f32_32x32x16_bf16 v[80:95], v[136:139], v[200:203], v[80:95]
  v_mfma_f32_32x32x16_bf16 v[96:111], v[136:139], v[204:207], v[96:111]
  s_add_u32 s90, s64, 158720
  buffer_load_dwordx4 v[160:163], v11, s[12:15], s90 offen sc1
  s_waitcnt vmcnt(11)
  v_mfma_f32_32x32x16_bf16 v[48:63], v[140:143], v[208:211], v[48:63]
  v_mfma_f32_32x32x16_bf16 v[64:79], v[140:143], v[212:215], v[64:79]
  s_waitcnt vmcnt(10)
  v_mfma_f32_32x32x16_bf16 v[80:95], v[4:7], v[208:211], v[80:95]
  v_mfma_f32_32x32x16_bf16 v[96:111], v[4:7], v[212:215], v[96:111]
  s_waitcnt vmcnt(9)
  v_mfma_f32_32x32x16_bf16 v[48:63], v[16:19], v[216:219], v[48:63]
  v_mfma_f32_32x32x16_bf16 v[64:79], v[16:19], v[220:223], v[64:79]
  s_waitcnt vmcnt(8)
  v_mfma_f32_32x32x16_bf16 v[80:95], v[144:147], v[216:219], v[80:95]
  v_mfma_f32_32x32x16_bf16 v[96:111], v[144:147], v[220:223], v[96:111]
  s_waitcnt vmcnt(7)
  v_mfma_f32_32x32x16_bf16 v[48:63], v[148:151], v[224:227], v[48:63]
  v_mfma_f32_32x32x16_bf16 v[64:79], v[148:151], v[228:231], v[64:79]
  s_waitcnt vmcnt(6)
  v_mfma_f32_32x32x16_bf16 v[80:95], v[20:23], v[224:227], v[80:95]
  v_mfma_f32_32x32x16_bf16 v[96:111], v[20:23], v[228:231], v[96:111]
  s_waitcnt vmcnt(5)
  v_mfma_f32_32x32x16_bf16 v[48:63], v[112:115], v[232:235], v[48:63]
  v_mfma_f32_32x32x16_bf16 v[64:79], v[112:115], v[236:239], v[64:79]
  s_waitcnt vmcnt(4)
  v_mfma_f32_32x32x16_bf16 v[80:95], v[152:155], v[232:235], v[80:95]
  v_mfma_f32_32x32x16_bf16 v[96:111], v[152:155], v[236:239], v[96:111]
  s_waitcnt vmcnt(3)
  v_mfma_f32_32x32x16_bf16 v[48:63], v[156:159], v[240:243], v[48:63]
  v_mfma_f32_32x32x16_bf16 v[64:79], v[156:159], v[244:247], v[64:79]
  s_waitcnt vmcnt(2)
  v_mfma_f32_32x32x16_bf16 v[80:95], v[116:119], v[240:243], v[80:95]
  v_mfma_f32_32x32x16_bf16 v[96:111], v[116:119], v[244:247], v[96:111]
  s_waitcnt vmcnt(1)
  v_mfma_f32_32x32x16_bf16 v[48:63], v[24:27], v[248:251], v[48:63]
  v_mfma_f32_32x32x16_bf16 v[64:79], v[24:27], v[252:255], v[64:79]
  s_waitcnt vmcnt(0)
  v_mfma_f32_32x32x16_bf16 v[80:95], v[160:163], v[248:251], v[80:95]
  v_mfma_f32_32x32x16_bf16 v[96:111], v[160:163], v[252:255], v[96:111]
  s_setprio 0
  s_xor_b32 s91, s77, 1
  s_mul_i32 s91, s91, 24576
  s_add_u32 s91, s91, 0
  v_add_u32 v4, s91, v15
  s_xor_b32 s91, s77, 2
  s_mul_i32 s91, s91, 24576
  s_add_u32 s91, s91, 4096
  v_add_u32 v5, s91, v15
  s_xor_b32 s91, s77, 3
  s_mul_i32 s91, s91, 24576
  s_add_u32 s91, s91, 8192
  v_add_u32 v6, s91, v15
  v_add_u32 v7, s95, v15
  v_add_u32 v8, s96, v15
  ds_write_b128 v4, v[52:55] offset:0
  ds_write_b128 v4, v[68:71] offset:1024
  ds_write_b128 v4, v[84:87] offset:2048
  ds_write_b128 v4, v[100:103] offset:3072
  ds_write_b128 v5, v[56:59] offset:0
  ds_write_b128 v5, v[72:75] offset:1024
  ds_write_b128 v5, v[88:91] offset:2048
  ds_write_b128 v5, v[104:107] offset:3072
  ds_write_b128 v6, v[60:63] offset:0
  ds_write_b128 v6, v[76:79] offset:1024
  ds_write_b128 v6, v[92:95] offset:2048
  ds_write_b128 v6, v[108:111] offset:3072
  s_waitcnt lgkmcnt(0)
  s_barrier
  ds_read_b128 v[112:115], v7 offset:0
  ds_read_b128 v[116:119], v7 offset:4096
  ds_read_b128 v[120:123], v7 offset:8192
  ds_read_b128 v[124:127], v7 offset:1024
  ds_read_b128 v[128:131], v7 offset:5120
  ds_read_b128 v[132:135], v7 offset:9216
  ds_read_b128 v[136:139], v7 offset:2048
  ds_read_b128 v[140:143], v7 offset:6144
  ds_read_b128 v[144:147], v7 offset:10240
  ds_read_b128 v[148:151], v7 offset:3072
  ds_read_b128 v[152:155], v7 offset:7168
  ds_read_b128 v[156:159], v7 offset:11264
  s_waitcnt lgkmcnt(9)
  v_add_f32 v48, v48, v112
  v_add_f32 v49, v49, v113
  v_add_f32 v50, v50, v114
  v_add_f32 v51, v51, v115
  v_add_f32 v48, v48, v116
  v_add_f32 v49, v49, v117
  v_add_f32 v50, v50, v118
  v_add_f32 v51, v51, v119
  v_add_f32 v48, v48, v120
  v_add_f32 v49, v49, v121
  v_add_f32 v50, v50, v122
  v_add_f32 v51, v51, v123
  s_waitcnt lgkmcnt(6)
  v_add_f32 v64, v64, v124
  v_add_f32 v65, v65, v125
  v_add_f32 v66, v66, v126
  v_add_f32 v67, v67, v127
  v_add_f32 v64, v64, v128
  v_add_f32 v65, v65, v129
  v_add_f32 v66, v66, v130
  v_add_f32 v67, v67, v131
  v_add_f32 v64, v64, v132
  v_add_f32 v65, v65, v133
  v_add_f32 v66, v66, v134
  v_add_f32 v67, v67, v135
  s_waitcnt lgkmcnt(3)
  v_add_f32 v80, v80, v136
  v_add_f32 v81, v81, v137
  v_add_f32 v82, v82, v138
  v_add_f32 v83, v83, v139
  v_add_f32 v80, v80, v140
  v_add_f32 v81, v81, v141
  v_add_f32 v82, v82, v142
  v_add_f32 v83, v83, v143
  v_add_f32 v80, v80, v144
  v_add_f32 v81, v81, v145
  v_add_f32 v82, v82, v146
  v_add_f32 v83, v83, v147
  s_waitcnt lgkmcnt(0)
  v_add_f32 v96, v96, v148
  v_add_f32 v97, v97, v149
  v_add_f32 v98, v98, v150
  v_add_f32 v99, v99, v151
  v_add_f32 v96, v96, v152
  v_add_f32 v97, v97, v153
  v_add_f32 v98, v98, v154
  v_add_f32 v99, v99, v155
  v_add_f32 v96, v96, v156
  v_add_f32 v97, v97, v157
  v_add_f32 v98, v98, v158
  v_add_f32 v99, v99, v159
  s_barrier
  s_setprio 1
  ds_read_b128 v[112:115], v7 offset:16384
  ds_read_b128 v[116:119], v7 offset:18432
  ds_read_b128 v[120:123], v7 offset:20480
  ds_read_b128 v[124:127], v7 offset:22528
  ds_read_b128 v[128:131], v7 offset:17408
  ds_read_b128 v[132:135], v7 offset:19456
  ds_read_b128 v[136:139], v7 offset:21504
  ds_read_b128 v[140:143], v7 offset:23552
  s_waitcnt lgkmcnt(4)
  v_add_f32 v48, v48, v112
  v_add_f32 v49, v49, v113
  v_add_f32 v50, v50, v114
  v_add_f32 v51, v51, v115
  v_add_f32 v48, v48, v116
  v_add_f32 v49, v49, v117
  v_add_f32 v50, v50, v118
  v_add_f32 v51, v51, v119
  v_add_f32 v48, v48, v120
  v_add_f32 v49, v49, v121
  v_add_f32 v50, v50, v122
  v_add_f32 v51, v51, v123
  v_add_f32 v48, v48, v124
  v_add_f32 v49, v49, v125
  v_add_f32 v50, v50, v126
  v_add_f32 v51, v51, v127
  s_mov_b32 s90, 0
  buffer_store_dword v48, v10, s[68:71], s90 offen offset:0 sc1
  buffer_store_dword v49, v10, s[68:71], s90 offen offset:2048 sc1
  s_mov_b32 s90, 4096
  buffer_store_dword v50, v10, s[68:71], s90 offen offset:0 sc1
  buffer_store_dword v51, v10, s[68:71], s90 offen offset:2048 sc1
  s_waitcnt lgkmcnt(0)
  v_add_f32 v64, v64, v128
  v_add_f32 v65, v65, v129
  v_add_f32 v66, v66, v130
  v_add_f32 v67, v67, v131
  v_add_f32 v64, v64, v132
  v_add_f32 v65, v65, v133
  v_add_f32 v66, v66, v134
  v_add_f32 v67, v67, v135
  v_add_f32 v64, v64, v136
  v_add_f32 v65, v65, v137
  v_add_f32 v66, v66, v138
  v_add_f32 v67, v67, v139
  v_add_f32 v64, v64, v140
  v_add_f32 v65, v65, v141
  v_add_f32 v66, v66, v142
  v_add_f32 v67, v67, v143
  s_mov_b32 s90, 0
  buffer_store_dword v64, v10, s[68:71], s90 offen offset:128 sc1
  buffer_store_dword v65, v10, s[68:71], s90 offen offset:2176 sc1
  s_mov_b32 s90, 4096
  buffer_store_dword v66, v10, s[68:71], s90 offen offset:128 sc1
  buffer_store_dword v67, v10, s[68:71], s90 offen offset:2176 sc1
  s_barrier
  ds_read_b128 v[112:115], v8 offset:0
  ds_read_b128 v[116:119], v8 offset:1024
  ds_read_b128 v[120:123], v8 offset:2048
  ds_read_b128 v[124:127], v8 offset:3072
  s_waitcnt lgkmcnt(2)
  v_pk_add_f32 v[80:81], v[80:81], v[112:113]
  v_pk_add_f32 v[82:83], v[82:83], v[114:115]
  v_pk_add_f32 v[80:81], v[80:81], v[116:117]
  v_pk_add_f32 v[82:83], v[82:83], v[118:119]
  s_waitcnt lgkmcnt(0)
  v_pk_add_f32 v[80:81], v[80:81], v[120:121]
  v_pk_add_f32 v[82:83], v[82:83], v[122:123]
  v_pk_add_f32 v[80:81], v[80:81], v[124:125]
  v_pk_add_f32 v[82:83], v[82:83], v[126:127]
  s_mov_b32 s90, 16384
  buffer_store_dword v80, v10, s[68:71], s90 offen offset:0 sc1
  buffer_store_dword v81, v10, s[68:71], s90 offen offset:2048 sc1
  s_mov_b32 s90, 20480
  buffer_store_dword v82, v10, s[68:71], s90 offen offset:0 sc1
  buffer_store_dword v83, v10, s[68:71], s90 offen offset:2048 sc1
  s_barrier
  ds_read_b128 v[128:131], v8 offset:16640
  ds_read_b128 v[132:135], v8 offset:17664
  ds_read_b128 v[136:139], v8 offset:18688
  ds_read_b128 v[140:143], v8 offset:19712
  s_waitcnt lgkmcnt(2)
  v_pk_add_f32 v[96:97], v[96:97], v[128:129]
  v_pk_add_f32 v[98:99], v[98:99], v[130:131]
  v_pk_add_f32 v[96:97], v[96:97], v[132:133]
  v_pk_add_f32 v[98:99], v[98:99], v[134:135]
  s_waitcnt lgkmcnt(0)
  v_pk_add_f32 v[96:97], v[96:97], v[136:137]
  v_pk_add_f32 v[98:99], v[98:99], v[138:139]
  v_pk_add_f32 v[96:97], v[96:97], v[140:141]
  v_pk_add_f32 v[98:99], v[98:99], v[142:143]
  s_mov_b32 s90, 16384
  buffer_store_dword v96, v10, s[68:71], s90 offen offset:128 sc1
  buffer_store_dword v97, v10, s[68:71], s90 offen offset:2176 sc1
  s_mov_b32 s90, 20480
  buffer_store_dword v98, v10, s[68:71], s90 offen offset:128 sc1
  buffer_store_dword v99, v10, s[68:71], s90 offen offset:2176 sc1
  s_endpgm
L_init:
  v_lshlrev_b32 v10, 4, v1
  v_add_u32 v10, 10551296, v10
  v_mov_b32 v44, 0
  v_mov_b32 v45, 0
  v_mov_b32 v46, 0
  v_mov_b32 v47, 0
  global_store_dwordx4 v10, v[44:47], s[66:67] offset:0 sc1
  global_store_dwordx4 v10, v[44:47], s[66:67] offset:1024 sc1
  s_branch L_initd
L_init2:
  v_mov_b32 v44, 0
  v_mov_b32 v45, 1
  s_mov_b64 exec, 1
  buffer_store_dword v45, v44, s[16:19], 0 offen sc1
  s_mov_b64 exec, -1
  s_branch L_init2d
L_go:
  s_mov_b32 s97, 0
L_go1:
  s_sleep 8
  buffer_load_dword v2, v3, s[16:19], s1 offen sc1
  s_add_u32 s97, s97, 1
  s_cmp_gt_u32 s97, 100000
  s_cbranch_scc1 L_gook
  s_waitcnt vmcnt(0)
  v_cmp_gt_u32 vcc, s0, v2
  s_nop 0
  s_cmp_eq_u64 vcc, 0
  s_cbranch_scc0 L_go1
  s_branch L_gook
L_poll:
  s_mov_b32 s97, 0
L_poll1:
  s_sleep 8
  buffer_load_dword v2, v3, s[12:15], s1 offen sc1
  s_add_u32 s97, s97, 1
  s_cmp_gt_u32 s97, 100000
  s_cbranch_scc1 L_pollok
  s_waitcnt vmcnt(0)
  v_cmp_gt_u32 vcc, s0, v2
  s_nop 0
  s_cmp_eq_u64 vcc, 0
  s_cbranch_scc0 L_poll1
  s_branch L_pollok
L_fp1:
  s_mov_b32 s97, 0
L_fp1_1:
  s_load_dword s55, s[66:67], s94 glc
  s_add_u32 s97, s97, 1
  s_waitcnt lgkmcnt(0)
  s_cmp_gt_u32 s97, 100000
  s_cselect_b32 s55, 6, s55
  s_cmp_lt_u32 s55, 6
  s_cbranch_scc0 L_fp1_ok
  s_sleep 2
  s_branch L_fp1_1
L_comp:
  s_lshr_b32 s90, s80, 3
  s_mul_i32 s3, s90, 22
  s_cmp_eq_u32 s90, 3
  s_subb_u32 s3, s3, 0
  s_cmp_lt_u32 s90, 2
  s_cselect_b32 s74, 1, 0
  s_and_b32 s90, s80, 7
  s_cmp_lt_u32 s90, 7
  s_cselect_b32 s74, 3, s74
  s_mul_i32 s90, s90, 3
  s_add_u32 s3, s3, s90
  s_mov_b32 s12, s66
  s_mov_b32 s13, s67
  s_mov_b32 s14, 11010048
  s_mov_b32 s15, 0x20000
  s_mov_b32 s28, s60
  s_mov_b32 s29, s61
  s_mov_b32 s30, 1409024
  s_mov_b32 s31, 0x20000
  v_lshlrev_b32 v6, 1, v4
  v_and_b32 v6, 4, v6
  v_xor_b32 v6, v5, v6
  v_lshlrev_b32 v6, 4, v6
  v_lshl_add_u32 v6, v4, 10, v6
  s_lshl_b32 s90, s87, 7
  v_add_u32 v14, s90, v6
  s_mul_i32 s93, s77, 22
  s_cmp_eq_u32 s77, 3
  s_cselect_b32 s90, 1, 0
  s_sub_u32 s93, s93, s90
  s_lshl_b32 s75, s93, 14
  s_lshl_b32 s96, s77, 12
  s_lshl_b32 s90, s90, 11
  s_sub_u32 s99, s96, s90
  s_add_u32 s99, s99, 148224
  s_add_u32 s96, s96, 98304
  s_lshl_b32 s98, s94, 2
  s_lshr_b32 s90, s80, 3
  s_add_u32 s98, s98, s90
  s_lshl_b32 s98, s98, 8
  s_add_u32 s98, s98, 10616832
  v_lshlrev_b32 v15, 4, v1
  v_and_b32 v2, 15, v1
  v_lshrrev_b32 v3, 4, v1
  v_bfe_u32 v6, v1, 1, 3
  v_xor_b32 v6, v3, v6
  v_lshlrev_b32 v6, 4, v6
  v_lshl_add_u32 v6, v2, 7, v6
  v_bfe_u32 v10, v1, 2, 3
  v_lshrrev_b32 v11, 5, v1
  v_lshl_add_u32 v10, v11, 4, v10
  v_mul_u32_u24 v10, 96, v10
  v_and_b32 v11, 3, v1
  v_lshl_add_u32 v10, v11, 3, v10
  s_lshl_b32 s90, s80, 12
  s_add_u32 s90, s90, 10878976
  s_add_u32 s32, s66, s90
  s_addc_u32 s33, s67, 0
  s_mov_b32 s34, 4096
  s_mov_b32 s35, 0x20000
  v_add_u32 v22, s95, v6
  v_xor_b32 v23, 64, v22
  v_add_u32 v24, 98304, v6
  v_xor_b32 v25, 64, v24
  v_add_u32 v26, 102400, v10
  v_lshl_add_u32 v27, v2, 4, s99
  v_and_b32 v28, 48, v1
  s_lshl_b32 s90, s77, 9
  s_add_u32 s90, s90, 161536
  v_lshl_add_u32 v29, v28, 2, s90
  v_add_u32 v28, 160512, v28
  v_lshlrev_b32 v30, 2, v2
  v_add_u32 v30, 160512, v30
  v_lshlrev_b32 v46, 4, v2
  v_and_b32 v0, 1, v1
  v_lshlrev_b32 v0, 4, v0
  v_mov_b32 v6, 0x3f80
  v_lshlrev_b32 v0, v0, v6
  v_bfe_u32 v6, v1, 2, 2
  v_cmp_eq_u32 vcc, v6, v3
  v_and_b32 v6, 2, v1
  v_mov_b32 v16, 0
  v_cndmask_b32 v0, 0, v0, vcc
  v_cmp_eq_u32 vcc, 0, v6
  v_mov_b32 v17, 0
  v_mov_b32 v20, 0
  v_cndmask_b32 v18, 0, v0, vcc
  v_cndmask_b32 v19, v0, 0, vcc
  v_mov_b32 v21, 0
  v_and_b32 v6, 31, v1
  v_lshrrev_b32 v7, 5, v1
  s_sub_u32 s91, 31, s94
  s_and_b32 s92, s91, 1
  s_lshr_b32 s91, s91, 1
  s_lshl_b32 s91, s91, 5
  s_add_u32 s91, s91, s92
  s_lshl_b32 s89, s91, 3
  s_lshl_b32 s91, s80, 12
  s_add_u32 s91, s91, s89
  s_add_u32 s91, s91, 10878720
  v_lshl_add_u32 v140, v6, 2, v7
  v_lshl_add_u32 v140, v140, 2, s91
  v_mov_b32 v141, -1
  s_and_b32 s91, s80, 7
  s_cselect_b32 s91, 0x40000000, s98
  v_cmp_gt_u32 vcc, 7, v6
  v_lshl_add_u32 v142, v7, 7, s91
  s_lshr_b32 s91, s72, 5
  v_cndmask_b32 v140, v140, v142, vcc
  v_cndmask_b32 v141, v141, 0, vcc
  s_lshl_b32 s91, s91, 9
  s_and_b32 s92, s72, 31
  s_lshl_b32 s92, s92, 3
  s_add_u32 s91, s91, s92
  s_add_u32 s91, s91, 10517504
  v_cmp_gt_u32 vcc, 6, v6
  v_lshl_add_u32 v142, v6, 6, v7
  v_lshl_add_u32 v142, v142, 2, s91
  v_cndmask_b32 v140, v140, v142, vcc
  s_lshl_b32 s91, s72, 5
  s_add_u32 s91, s91, 10485760
  v_cmp_gt_u32 vcc, 4, v6
  v_lshl_add_u32 v142, v7, 2, v6
  v_lshl_add_u32 v142, v142, 2, s91
  v_cndmask_b32 v140, v140, v142, vcc
  s_mul_i32 s94, s94, 307200
  s_add_u32 s92, s3, 0
  s_lshl_b32 s92, s92, 10
  s_add_u32 s92, s92, s94
  s_cmp_gt_u32 s74, 0
  s_cselect_b32 s81, s92, 0x40000000
  s_add_u32 s92, s3, 1
  s_lshl_b32 s92, s92, 10
  s_add_u32 s92, s92, s94
  s_cmp_gt_u32 s74, 1
  s_cselect_b32 s82, s92, 0x40000000
  s_add_u32 s92, s3, 2
  s_lshl_b32 s92, s92, 10
  s_add_u32 s92, s92, s94
  s_cmp_gt_u32 s74, 2
  s_cselect_b32 s83, s92, 0x40000000
  s_and_b32 s90, s80, 7
  s_cmp_lt_u32 s90, 6
  s_cselect_b32 s84, s98, 0x40000000
  s_add_u32 s98, s98, 128
  s_add_u32 s88, s80, 86
  s_lshl_b32 s88, s88, 10
  s_add_u32 s88, s88, s94
  s_waitcnt vmcnt(2)
  v_lshlrev_b32 v244, 16, v244
  v_lshlrev_b32 v245, 16, v245
  v_lshlrev_b32 v246, 16, v246
  v_mul_f32 v246, 0x3fb8aa3b, v246
  v_exp_f32 v246, v246
  s_nop 0
  v_cvt_pk_bf16_f32 v246, v246, v246
  v_lshlrev_b32 v246, 16, v246
  v_mul_f32 v247, v246, v244
  v_mul_f32 v248, v246, v245
  v_mul_f32 v247, 0x3fb8aa3b, v247
  v_mul_f32 v248, 0.15915494, v248
  v_mul_f32 v249, 1.0, v247
  v_mul_f32 v250, 1.0, v248
  v_rndne_f32 v251, v250
  v_exp_f32 v249, v249
  v_sub_f32 v250, v250, v251
  v_cos_f32 v251, v250
  v_sin_f32 v250, v250
  v_mul_f32 v80, v249, v251
  v_mul_f32 v96, v249, v250
  v_mul_f32 v81, v80, v80
  v_mul_f32 v97, v80, v96
  v_fma_f32 v81, -v96, v96, v81
  v_fmac_f32 v97, v96, v80
  v_mul_f32 v82, v80, v81
  v_mul_f32 v98, v80, v97
  v_fma_f32 v82, -v96, v97, v82
  v_fmac_f32 v98, v96, v81
  v_mul_f32 v83, v81, v81
  v_mul_f32 v99, v81, v97
  v_fma_f32 v83, -v97, v97, v83
  v_fmac_f32 v99, v97, v81
  v_mul_f32 v84, v81, v82
  v_mul_f32 v100, v81, v98
  v_fma_f32 v84, -v97, v98, v84
  v_fmac_f32 v100, v97, v82
  v_mul_f32 v85, v82, v82
  v_mul_f32 v101, v82, v98
  v_fma_f32 v85, -v98, v98, v85
  v_fmac_f32 v101, v98, v82
  v_mul_f32 v86, v82, v83
  v_mul_f32 v102, v82, v99
  v_fma_f32 v86, -v98, v99, v86
  v_fmac_f32 v102, v98, v83
  v_mul_f32 v87, v83, v83
  v_mul_f32 v103, v83, v99
  v_fma_f32 v87, -v99, v99, v87
  v_fmac_f32 v103, v99, v83
  v_mul_f32 v88, v83, v84
  v_mul_f32 v104, v83, v100
  v_fma_f32 v88, -v99, v100, v88
  v_fmac_f32 v104, v99, v84
  v_mul_f32 v89, v84, v84
  v_mul_f32 v105, v84, v100
  v_fma_f32 v89, -v100, v100, v89
  v_fmac_f32 v105, v100, v84
  v_mul_f32 v90, v84, v85
  v_mul_f32 v106, v84, v101
  v_fma_f32 v90, -v100, v101, v90
  v_fmac_f32 v106, v100, v85
  v_mul_f32 v91, v85, v85
  v_mul_f32 v107, v85, v101
  v_fma_f32 v91, -v101, v101, v91
  v_fmac_f32 v107, v101, v85
  v_mul_f32 v92, v85, v86
  v_mul_f32 v108, v85, v102
  v_fma_f32 v92, -v101, v102, v92
  v_fmac_f32 v108, v101, v86
  v_mul_f32 v93, v86, v86
  v_mul_f32 v109, v86, v102
  v_fma_f32 v93, -v102, v102, v93
  v_fmac_f32 v109, v102, v86
  v_mul_f32 v94, v86, v87
  v_mul_f32 v110, v86, v103
  v_fma_f32 v94, -v102, v103, v94
  v_fmac_f32 v110, v102, v87
  v_mul_f32 v95, v87, v87
  v_mul_f32 v111, v87, v103
  v_fma_f32 v95, -v103, v103, v95
  v_fmac_f32 v111, v103, v87
  v_mul_f32 v249, 0x42000000, v247
  v_mul_f32 v250, 0x42000000, v248
  v_rndne_f32 v251, v250
  v_exp_f32 v249, v249
  v_sub_f32 v250, v250, v251
  v_cos_f32 v251, v250
  v_sin_f32 v250, v250
  v_mul_f32 v38, v249, v251
  v_mul_f32 v39, v249, v250
  v_mul_f32 v249, 0x42800000, v247
  v_mul_f32 v250, 0x42800000, v248
  v_rndne_f32 v251, v250
  v_exp_f32 v249, v249
  v_sub_f32 v250, v250, v251
  v_cos_f32 v251, v250
  v_sin_f32 v250, v250
  v_mul_f32 v32, v249, v251
  v_mul_f32 v33, v249, v250
  v_and_b32 v252, 16, v1
  v_cvt_f32_u32 v252, v252
  v_mul_f32 v249, v252, v247
  v_mul_f32 v250, v252, v248
  v_rndne_f32 v251, v250
  v_exp_f32 v249, v249
  v_sub_f32 v250, v250, v251
  v_cos_f32 v251, v250
  v_sin_f32 v250, v250
  v_mul_f32 v40, v249, v251
  v_mul_f32 v41, v249, v250
  v_and_b32 v252, 48, v1
  v_cvt_f32_u32 v252, v252
  v_mul_f32 v249, v252, v247
  v_mul_f32 v250, v252, v248
  v_rndne_f32 v251, v250
  v_exp_f32 v249, v249
  v_sub_f32 v250, v250, v251
  v_cos_f32 v251, v250
  v_sin_f32 v250, v250
  v_mul_f32 v34, v249, v251
  v_mul_f32 v35, v249, v250
  s_bitcmp1_b32 s77, 0
  s_cselect_b32 s90, 0xc2800000, 0
  v_mul_f32 v252, 0x42000000, v252
  v_add_f32 v252, s90, v252
  v_max_f32 v252, 0, v252
  v_mul_f32 v249, v252, v247
  v_mul_f32 v250, v252, v248
  v_rndne_f32 v251, v250
  v_exp_f32 v249, v249
  v_sub_f32 v250, v250, v251
  v_cos_f32 v251, v250
  v_sin_f32 v250, v250
  v_mul_f32 v254, v249, v251
  v_mul_f32 v255, v249, v250
  v_mul_f32 v249, v244, v244
  v_fmac_f32 v249, v245, v245
  v_rcp_f32 v249, v249
  v_add_f32 v250, -1.0, v80
  v_mul_f32 v42, v250, v244
  v_fmac_f32 v42, v96, v245
  v_mul_f32 v43, v96, v244
  v_fma_f32 v43, -v250, v245, v43
  v_add_f32 v249, v249, v249
  v_mul_f32 v42, v249, v42
  v_mul_f32 v43, v249, v43
  v_mul_f32 v36, v42, v254
  v_mul_f32 v37, v42, v255
  v_fma_f32 v36, -v43, v255, v36
  v_fmac_f32 v37, v43, v254
  v_sub_f32 v47, 0, v96
  s_waitcnt vmcnt(0)
  v_lshlrev_b32 v120, 16, v112
  v_and_b32 v121, 0xffff0000, v112
  v_lshlrev_b32 v122, 16, v113
  v_and_b32 v123, 0xffff0000, v113
  v_lshlrev_b32 v124, 16, v114
  v_and_b32 v125, 0xffff0000, v114
  v_lshlrev_b32 v126, 16, v115
  v_and_b32 v127, 0xffff0000, v115
  v_lshlrev_b32 v128, 16, v116
  v_and_b32 v129, 0xffff0000, v116
  v_lshlrev_b32 v130, 16, v117
  v_and_b32 v131, 0xffff0000, v117
  v_lshlrev_b32 v132, 16, v118
  v_and_b32 v133, 0xffff0000, v118
  v_lshlrev_b32 v134, 16, v119
  v_and_b32 v135, 0xffff0000, v119
  v_pk_add_f32 v[136:137], v[120:121], v[122:123]
  v_pk_add_f32 v[136:137], v[136:137], v[124:125]
  v_pk_add_f32 v[136:137], v[136:137], v[126:127]
  v_pk_add_f32 v[136:137], v[136:137], v[128:129]
  v_pk_add_f32 v[136:137], v[136:137], v[130:131]
  v_pk_add_f32 v[136:137], v[136:137], v[132:133]
  v_pk_add_f32 v[136:137], v[136:137], v[134:135]
  v_add_f32 v136, v136, v137
  s_nop 1
  v_add_f32_dpp v136, v136, v136 row_ror:8 row_mask:0xf bank_mask:0xf
  s_nop 1
  v_add_f32_dpp v136, v136, v136 row_ror:4 row_mask:0xf bank_mask:0xf
  s_nop 1
  v_add_f32_dpp v136, v136, v136 row_ror:2 row_mask:0xf bank_mask:0xf
  s_nop 1
  v_add_f32_dpp v136, v136, v136 row_ror:1 row_mask:0xf bank_mask:0xf
  v_mov_b32 v137, v136
  s_nop 1
  v_permlane16_swap_b32 v137, v136
  v_add_f32 v136, v136, v137
  v_mul_f32 v136, 0x3b000000, v136
  v_pk_add_f32 v[120:121], v[120:121], v[136:137] op_sel_hi:[1,0] neg_lo:[0,1] neg_hi:[0,1]
  v_pk_add_f32 v[122:123], v[122:123], v[136:137] op_sel_hi:[1,0] neg_lo:[0,1] neg_hi:[0,1]
  v_pk_add_f32 v[124:125], v[124:125], v[136:137] op_sel_hi:[1,0] neg_lo:[0,1] neg_hi:[0,1]
  v_pk_add_f32 v[126:127], v[126:127], v[136:137] op_sel_hi:[1,0] neg_lo:[0,1] neg_hi:[0,1]
  v_pk_add_f32 v[128:129], v[128:129], v[136:137] op_sel_hi:[1,0] neg_lo:[0,1] neg_hi:[0,1]
  v_pk_add_f32 v[130:131], v[130:131], v[136:137] op_sel_hi:[1,0] neg_lo:[0,1] neg_hi:[0,1]
  v_pk_add_f32 v[132:133], v[132:133], v[136:137] op_sel_hi:[1,0] neg_lo:[0,1] neg_hi:[0,1]
  v_pk_add_f32 v[134:135], v[134:135], v[136:137] op_sel_hi:[1,0] neg_lo:[0,1] neg_hi:[0,1]
  v_pk_mul_f32 v[138:139], v[120:121], v[120:121]
  v_pk_fma_f32 v[138:139], v[122:123], v[122:123], v[138:139]
  v_pk_fma_f32 v[138:139], v[124:125], v[124:125], v[138:139]
  v_pk_fma_f32 v[138:139], v[126:127], v[126:127], v[138:139]
  v_pk_fma_f32 v[138:139], v[128:129], v[128:129], v[138:139]
  v_pk_fma_f32 v[138:139], v[130:131], v[130:131], v[138:139]
  v_pk_fma_f32 v[138:139], v[132:133], v[132:133], v[138:139]
  v_pk_fma_f32 v[138:139], v[134:135], v[134:135], v[138:139]
  v_add_f32 v138, v138, v139
  s_nop 1
  v_add_f32_dpp v138, v138, v138 row_ror:8 row_mask:0xf bank_mask:0xf
  s_nop 1
  v_add_f32_dpp v138, v138, v138 row_ror:4 row_mask:0xf bank_mask:0xf
  s_nop 1
  v_add_f32_dpp v138, v138, v138 row_ror:2 row_mask:0xf bank_mask:0xf
  s_nop 1
  v_add_f32_dpp v138, v138, v138 row_ror:1 row_mask:0xf bank_mask:0xf
  v_mov_b32 v139, v138
  s_nop 1
  v_permlane16_swap_b32 v139, v138
  v_add_f32 v138, v138, v139
  v_mul_f32 v138, 0x3b000000, v138
  v_cvt_pk_bf16_f32 v136, v136, v138
  v_and_b32 v138, 0xffff0000, v136
  v_lshlrev_b32 v136, 16, v136
  v_add_f32 v138, 0x3727c5ac, v138
  v_cvt_pk_bf16_f32 v138, v138, v138
  v_lshlrev_b32 v138, 16, v138
  v_sqrt_f32 v138, v138
  v_sub_f32 v123, 0, v136
  v_cvt_pk_bf16_f32 v138, v138, v138
  v_lshlrev_b32 v138, 16, v138
  v_mul_f32 v122, v138, v138
  v_rcp_f32 v138, v138
  s_mov_b32 s90, 8
  s_mov_b32 s91, 8
  v_mul_f32 v120, 0xc0135761, v138
  v_mul_f32 v121, v138, v138
  v_mul_f32 v125, v123, v138
  v_mul_f32 v121, 0x3d372713, v121
  v_cndmask_b32 v141, v141, v123, s[90:91]
  v_mul_f32 v121, v121, v120
  s_mov_b32 vcc_lo, 32
  s_mov_b32 vcc_hi, 32
  v_cndmask_b32 v141, v141, v125, vcc
  s_mov_b32 vcc_lo, 16
  s_mov_b32 vcc_hi, 16
  v_cndmask_b32 v141, v141, v138, vcc
  s_mov_b32 vcc_lo, 4
  s_mov_b32 vcc_hi, 4
  v_cndmask_b32 v141, v141, v122, vcc
  s_mov_b32 vcc_lo, 2
  s_mov_b32 vcc_hi, 2
  v_cndmask_b32 v141, v141, v121, vcc
  s_mov_b32 vcc_lo, 1
  s_mov_b32 vcc_hi, 1
  v_cndmask_b32 v141, v141, v120, vcc
  s_mov_b32 exec_lo, 0xffff007f
  s_mov_b32 exec_hi, 0xffff007f
  buffer_store_dword v141, v140, s[12:15], 0 offen sc1
  s_mov_b64 exec, -1
  s_setprio 0
  s_barrier
  ds_read_b128 v[240:243], v24 offset:0
  ds_read_b128 v[208:211], v22 offset:0
  ds_read_b128 v[212:215], v22 offset:2048
  ds_read_b128 v[216:219], v22 offset:4096
  ds_read_b128 v[220:223], v22 offset:6144
  ds_read_b128 v[244:247], v24 offset:2048
  ds_read_b64_tr_b16 v[248:249], v26 offset:0
  ds_read_b64_tr_b16 v[250:251], v26 offset:768
  s_waitcnt lgkmcnt(3)
  v_mfma_f32_16x16x32_bf16 v[48:51], v[208:211], v[240:243], 0
  ds_read_b64_tr_b16 v[252:253], v26 offset:6272
  v_mfma_f32_16x16x32_bf16 v[52:55], v[212:215], v[240:243], 0
  ds_read_b64_tr_b16 v[254:255], v26 offset:7040
  v_mfma_f32_16x16x32_bf16 v[56:59], v[216:219], v[240:243], 0
  v_mfma_f32_16x16x32_bf16 v[60:63], v[220:223], v[240:243], 0
  s_waitcnt lgkmcnt(4)
  v_mfma_f32_16x16x32_bf16 v[64:67], v[208:211], v[244:247], 0
  ds_read_b64_tr_b16 v[240:241], v26 offset:32
  v_mfma_f32_16x16x32_bf16 v[68:71], v[212:215], v[244:247], 0
  ds_read_b64_tr_b16 v[242:243], v26 offset:800
  v_mfma_f32_16x16x32_bf16 v[72:75], v[216:219], v[244:247], 0
  v_mfma_f32_16x16x32_bf16 v[76:79], v[220:223], v[244:247], 0
  s_waitcnt lgkmcnt(4)
  v_mfma_f32_16x16x32_bf16 v[112:115], v[248:251], v[208:211], 0
  ds_read_b64_tr_b16 v[244:245], v26 offset:6304
  v_mfma_f32_16x16x32_bf16 v[116:119], v[248:251], v[212:215], 0
  ds_read_b64_tr_b16 v[246:247], v26 offset:7072
  v_mfma_f32_16x16x32_bf16 v[120:123], v[248:251], v[216:219], 0
  v_mfma_f32_16x16x32_bf16 v[124:127], v[248:251], v[220:223], 0
  s_waitcnt lgkmcnt(4)
  v_mfma_f32_16x16x32_bf16 v[128:131], v[252:255], v[208:211], 0
  ds_read_b64_tr_b16 v[248:249], v26 offset:64
  v_mfma_f32_16x16x32_bf16 v[132:135], v[252:255], v[212:215], 0
  ds_read_b64_tr_b16 v[250:251], v26 offset:832
  v_mfma_f32_16x16x32_bf16 v[136:139], v[252:255], v[216:219], 0
  v_mfma_f32_16x16x32_bf16 v[140:143], v[252:255], v[220:223], 0
  s_waitcnt lgkmcnt(4)
  v_mfma_f32_16x16x32_bf16 v[144:147], v[240:243], v[208:211], 0
  ds_read_b64_tr_b16 v[252:253], v26 offset:6336
  v_mfma_f32_16x16x32_bf16 v[148:151], v[240:243], v[212:215], 0
  ds_read_b64_tr_b16 v[254:255], v26 offset:7104
  v_mfma_f32_16x16x32_bf16 v[152:155], v[240:243], v[216:219], 0
  v_mfma_f32_16x16x32_bf16 v[156:159], v[240:243], v[220:223], 0
  s_waitcnt lgkmcnt(4)
  v_mfma_f32_16x16x32_bf16 v[160:163], v[244:247], v[208:211], 0
  ds_read_b128 v[240:243], v25 offset:0
  v_mfma_f32_16x16x32_bf16 v[164:167], v[244:247], v[212:215], 0
  ds_read_b128 v[224:227], v23 offset:0
  v_mfma_f32_16x16x32_bf16 v[168:171], v[244:247], v[216:219], 0
  ds_read_b128 v[228:231], v23 offset:2048
  v_mfma_f32_16x16x32_bf16 v[172:175], v[244:247], v[220:223], 0
  s_waitcnt lgkmcnt(5)
  v_mfma_f32_16x16x32_bf16 v[176:179], v[248:251], v[208:211], 0
  ds_read_b128 v[244:247], v25 offset:2048
  v_mfma_f32_16x16x32_bf16 v[180:183], v[248:251], v[212:215], 0
  ds_read_b128 v[232:235], v23 offset:4096
  v_mfma_f32_16x16x32_bf16 v[184:187], v[248:251], v[216:219], 0
  ds_read_b128 v[236:239], v23 offset:6144
  v_mfma_f32_16x16x32_bf16 v[188:191], v[248:251], v[220:223], 0
  s_waitcnt lgkmcnt(6)
  v_mfma_f32_16x16x32_bf16 v[192:195], v[252:255], v[208:211], 0
  ds_read_b64_tr_b16 v[248:249], v26 offset:3072
  v_mfma_f32_16x16x32_bf16 v[196:199], v[252:255], v[212:215], 0
  ds_read_b64_tr_b16 v[250:251], v26 offset:3840
  v_mfma_f32_16x16x32_bf16 v[200:203], v[252:255], v[216:219], 0
  v_mfma_f32_16x16x32_bf16 v[204:207], v[252:255], v[220:223], 0
  s_waitcnt lgkmcnt(2)
  v_mfma_f32_16x16x32_bf16 v[48:51], v[224:227], v[240:243], v[48:51]
  ds_read_b64_tr_b16 v[252:253], v26 offset:9344
  v_mfma_f32_16x16x32_bf16 v[52:55], v[228:231], v[240:243], v[52:55]
  ds_read_b64_tr_b16 v[254:255], v26 offset:10112
  v_mfma_f32_16x16x32_bf16 v[56:59], v[232:235], v[240:243], v[56:59]
  v_mfma_f32_16x16x32_bf16 v[60:63], v[236:239], v[240:243], v[60:63]
  s_waitcnt lgkmcnt(6)
  v_mfma_f32_16x16x32_bf16 v[64:67], v[224:227], v[244:247], v[64:67]
  ds_read_b64_tr_b16 v[240:241], v26 offset:3104
  v_mfma_f32_16x16x32_bf16 v[68:71], v[228:231], v[244:247], v[68:71]
  ds_read_b64_tr_b16 v[242:243], v26 offset:3872
  v_mfma_f32_16x16x32_bf16 v[72:75], v[232:235], v[244:247], v[72:75]
  v_mfma_f32_16x16x32_bf16 v[76:79], v[236:239], v[244:247], v[76:79]
  s_waitcnt lgkmcnt(4)
  v_mfma_f32_16x16x32_bf16 v[112:115], v[248:251], v[224:227], v[112:115]
  ds_read_b64_tr_b16 v[244:245], v26 offset:9376
  v_mfma_f32_16x16x32_bf16 v[116:119], v[248:251], v[228:231], v[116:119]
  ds_read_b64_tr_b16 v[246:247], v26 offset:10144
  v_mfma_f32_16x16x32_bf16 v[120:123], v[248:251], v[232:235], v[120:123]
  v_mfma_f32_16x16x32_bf16 v[124:127], v[248:251], v[236:239], v[124:127]
  s_waitcnt lgkmcnt(4)
  v_mfma_f32_16x16x32_bf16 v[128:131], v[252:255], v[224:227], v[128:131]
  ds_read_b64_tr_b16 v[248:249], v26 offset:3136
  v_mfma_f32_16x16x32_bf16 v[132:135], v[252:255], v[228:231], v[132:135]
  ds_read_b64_tr_b16 v[250:251], v26 offset:3904
  v_mfma_f32_16x16x32_bf16 v[136:139], v[252:255], v[232:235], v[136:139]
  v_mfma_f32_16x16x32_bf16 v[140:143], v[252:255], v[236:239], v[140:143]
  s_waitcnt lgkmcnt(4)
  v_mfma_f32_16x16x32_bf16 v[144:147], v[240:243], v[224:227], v[144:147]
  ds_read_b64_tr_b16 v[252:253], v26 offset:9408
  v_mfma_f32_16x16x32_bf16 v[148:151], v[240:243], v[228:231], v[148:151]
  ds_read_b64_tr_b16 v[254:255], v26 offset:10176
  v_mfma_f32_16x16x32_bf16 v[152:155], v[240:243], v[232:235], v[152:155]
  v_mfma_f32_16x16x32_bf16 v[156:159], v[240:243], v[236:239], v[156:159]
  s_waitcnt lgkmcnt(0)
  s_barrier
  v_mfma_f32_16x16x32_bf16 v[160:163], v[244:247], v[224:227], v[160:163]
  ds_read_b128 v[240:243], v24 offset:16640
  v_mfma_f32_16x16x32_bf16 v[164:167], v[244:247], v[228:231], v[164:167]
  ds_read_b128 v[208:211], v22 offset:8192
  v_mfma_f32_16x16x32_bf16 v[168:171], v[244:247], v[232:235], v[168:171]
  ds_read_b128 v[212:215], v22 offset:10240
  v_mfma_f32_16x16x32_bf16 v[172:175], v[244:247], v[236:239], v[172:175]
  s_waitcnt lgkmcnt(5)
  v_mfma_f32_16x16x32_bf16 v[176:179], v[248:251], v[224:227], v[176:179]
  ds_read_b128 v[244:247], v24 offset:18688
  v_mfma_f32_16x16x32_bf16 v[180:183], v[248:251], v[228:231], v[180:183]
  ds_read_b128 v[216:219], v22 offset:12288
  v_mfma_f32_16x16x32_bf16 v[184:187], v[248:251], v[232:235], v[184:187]
  ds_read_b128 v[220:223], v22 offset:14336
  v_mfma_f32_16x16x32_bf16 v[188:191], v[248:251], v[236:239], v[188:191]
  s_waitcnt lgkmcnt(6)
  v_mfma_f32_16x16x32_bf16 v[192:195], v[252:255], v[224:227], v[192:195]
  ds_read_b64_tr_b16 v[248:249], v26 offset:16640
  v_mfma_f32_16x16x32_bf16 v[196:199], v[252:255], v[228:231], v[196:199]
  ds_read_b64_tr_b16 v[250:251], v26 offset:17408
  v_mfma_f32_16x16x32_bf16 v[200:203], v[252:255], v[232:235], v[200:203]
  v_mfma_f32_16x16x32_bf16 v[204:207], v[252:255], v[236:239], v[204:207]
  s_waitcnt lgkmcnt(2)
  v_mfma_f32_16x16x32_bf16 v[48:51], v[208:211], v[240:243], v[48:51]
  ds_read_b64_tr_b16 v[252:253], v26 offset:22912
  v_mfma_f32_16x16x32_bf16 v[52:55], v[212:215], v[240:243], v[52:55]
  ds_read_b64_tr_b16 v[254:255], v26 offset:23680
  v_mfma_f32_16x16x32_bf16 v[56:59], v[216:219], v[240:243], v[56:59]
  v_mfma_f32_16x16x32_bf16 v[60:63], v[220:223], v[240:243], v[60:63]
  s_waitcnt lgkmcnt(6)
  v_mfma_f32_16x16x32_bf16 v[64:67], v[208:211], v[244:247], v[64:67]
  ds_read_b64_tr_b16 v[240:241], v26 offset:16672
  v_mfma_f32_16x16x32_bf16 v[68:71], v[212:215], v[244:247], v[68:71]
  ds_read_b64_tr_b16 v[242:243], v26 offset:17440
  v_mfma_f32_16x16x32_bf16 v[72:75], v[216:219], v[244:247], v[72:75]
  v_mfma_f32_16x16x32_bf16 v[76:79], v[220:223], v[244:247], v[76:79]
  s_waitcnt lgkmcnt(4)
  v_mfma_f32_16x16x32_bf16 v[112:115], v[248:251], v[208:211], v[112:115]
  ds_read_b64_tr_b16 v[244:245], v26 offset:22944
  v_mfma_f32_16x16x32_bf16 v[116:119], v[248:251], v[212:215], v[116:119]
  ds_read_b64_tr_b16 v[246:247], v26 offset:23712
  v_mfma_f32_16x16x32_bf16 v[120:123], v[248:251], v[216:219], v[120:123]
  v_mfma_f32_16x16x32_bf16 v[124:127], v[248:251], v[220:223], v[124:127]
  s_waitcnt lgkmcnt(4)
  v_mfma_f32_16x16x32_bf16 v[128:131], v[252:255], v[208:211], v[128:131]
  ds_read_b64_tr_b16 v[248:249], v26 offset:16704
  v_mfma_f32_16x16x32_bf16 v[132:135], v[252:255], v[212:215], v[132:135]
  ds_read_b64_tr_b16 v[250:251], v26 offset:17472
  v_mfma_f32_16x16x32_bf16 v[136:139], v[252:255], v[216:219], v[136:139]
  v_mfma_f32_16x16x32_bf16 v[140:143], v[252:255], v[220:223], v[140:143]
  s_waitcnt lgkmcnt(4)
  v_mfma_f32_16x16x32_bf16 v[144:147], v[240:243], v[208:211], v[144:147]
  ds_read_b64_tr_b16 v[252:253], v26 offset:22976
  v_mfma_f32_16x16x32_bf16 v[148:151], v[240:243], v[212:215], v[148:151]
  ds_read_b64_tr_b16 v[254:255], v26 offset:23744
  v_mfma_f32_16x16x32_bf16 v[152:155], v[240:243], v[216:219], v[152:155]
  v_mfma_f32_16x16x32_bf16 v[156:159], v[240:243], v[220:223], v[156:159]
  s_waitcnt lgkmcnt(4)
  v_mfma_f32_16x16x32_bf16 v[160:163], v[244:247], v[208:211], v[160:163]
  ds_read_b128 v[240:243], v25 offset:16640
  v_mfma_f32_16x16x32_bf16 v[164:167], v[244:247], v[212:215], v[164:167]
  ds_read_b128 v[224:227], v23 offset:8192
  v_mfma_f32_16x16x32_bf16 v[168:171], v[244:247], v[216:219], v[168:171]
  ds_read_b128 v[228:231], v23 offset:10240
  v_mfma_f32_16x16x32_bf16 v[172:175], v[244:247], v[220:223], v[172:175]
  s_waitcnt lgkmcnt(5)
  v_mfma_f32_16x16x32_bf16 v[176:179], v[248:251], v[208:211], v[176:179]
  ds_read_b128 v[244:247], v25 offset:18688
  v_mfma_f32_16x16x32_bf16 v[180:183], v[248:251], v[212:215], v[180:183]
  ds_read_b128 v[232:235], v23 offset:12288
  v_mfma_f32_16x16x32_bf16 v[184:187], v[248:251], v[216:219], v[184:187]
  ds_read_b128 v[236:239], v23 offset:14336
  v_mfma_f32_16x16x32_bf16 v[188:191], v[248:251], v[220:223], v[188:191]
  s_waitcnt lgkmcnt(6)
  v_mfma_f32_16x16x32_bf16 v[192:195], v[252:255], v[208:211], v[192:195]
  ds_read_b64_tr_b16 v[248:249], v26 offset:19712
  v_mfma_f32_16x16x32_bf16 v[196:199], v[252:255], v[212:215], v[196:199]
  ds_read_b64_tr_b16 v[250:251], v26 offset:20480
  v_mfma_f32_16x16x32_bf16 v[200:203], v[252:255], v[216:219], v[200:203]
  v_mfma_f32_16x16x32_bf16 v[204:207], v[252:255], v[220:223], v[204:207]
  s_waitcnt lgkmcnt(2)
  v_mfma_f32_16x16x32_bf16 v[48:51], v[224:227], v[240:243], v[48:51]
  ds_read_b64_tr_b16 v[252:253], v26 offset:25984
  v_mfma_f32_16x16x32_bf16 v[52:55], v[228:231], v[240:243], v[52:55]
  ds_read_b64_tr_b16 v[254:255], v26 offset:26752
  v_mfma_f32_16x16x32_bf16 v[56:59], v[232:235], v[240:243], v[56:59]
  v_mfma_f32_16x16x32_bf16 v[60:63], v[236:239], v[240:243], v[60:63]
  s_waitcnt lgkmcnt(6)
  v_mfma_f32_16x16x32_bf16 v[64:67], v[224:227], v[244:247], v[64:67]
  ds_read_b64_tr_b16 v[240:241], v26 offset:19744
  v_mfma_f32_16x16x32_bf16 v[68:71], v[228:231], v[244:247], v[68:71]
  ds_read_b64_tr_b16 v[242:243], v26 offset:20512
  v_mfma_f32_16x16x32_bf16 v[72:75], v[232:235], v[244:247], v[72:75]
  v_mfma_f32_16x16x32_bf16 v[76:79], v[236:239], v[244:247], v[76:79]
  s_waitcnt lgkmcnt(4)
  v_mfma_f32_16x16x32_bf16 v[112:115], v[248:251], v[224:227], v[112:115]
  ds_read_b64_tr_b16 v[244:245], v26 offset:26016
  v_mfma_f32_16x16x32_bf16 v[116:119], v[248:251], v[228:231], v[116:119]
  ds_read_b64_tr_b16 v[246:247], v26 offset:26784
  v_mfma_f32_16x16x32_bf16 v[120:123], v[248:251], v[232:235], v[120:123]
  v_mfma_f32_16x16x32_bf16 v[124:127], v[248:251], v[236:239], v[124:127]
  s_waitcnt lgkmcnt(4)
  v_mfma_f32_16x16x32_bf16 v[128:131], v[252:255], v[224:227], v[128:131]
  ds_read_b64_tr_b16 v[248:249], v26 offset:19776
  v_mfma_f32_16x16x32_bf16 v[132:135], v[252:255], v[228:231], v[132:135]
  ds_read_b64_tr_b16 v[250:251], v26 offset:20544
  v_mfma_f32_16x16x32_bf16 v[136:139], v[252:255], v[232:235], v[136:139]
  v_mfma_f32_16x16x32_bf16 v[140:143], v[252:255], v[236:239], v[140:143]
  s_waitcnt lgkmcnt(4)
  v_mfma_f32_16x16x32_bf16 v[144:147], v[240:243], v[224:227], v[144:147]
  ds_read_b64_tr_b16 v[252:253], v26 offset:26048
  v_mfma_f32_16x16x32_bf16 v[148:151], v[240:243], v[228:231], v[148:151]
  ds_read_b64_tr_b16 v[254:255], v26 offset:26816
  v_mfma_f32_16x16x32_bf16 v[152:155], v[240:243], v[232:235], v[152:155]
  v_mfma_f32_16x16x32_bf16 v[156:159], v[240:243], v[236:239], v[156:159]
  s_waitcnt vmcnt(0) lgkmcnt(0)
  s_barrier
  v_mfma_f32_16x16x32_bf16 v[160:163], v[244:247], v[224:227], v[160:163]
  ds_read_b128 v[240:243], v24 offset:33280
  v_mfma_f32_16x16x32_bf16 v[164:167], v[244:247], v[228:231], v[164:167]
  ds_read_b128 v[208:211], v22 offset:16384
  v_mfma_f32_16x16x32_bf16 v[168:171], v[244:247], v[232:235], v[168:171]
  ds_read_b128 v[212:215], v22 offset:18432
  v_mfma_f32_16x16x32_bf16 v[172:175], v[244:247], v[236:239], v[172:175]
  s_waitcnt lgkmcnt(5)
  v_mfma_f32_16x16x32_bf16 v[176:179], v[248:251], v[224:227], v[176:179]
  ds_read_b128 v[244:247], v24 offset:35328
  v_mfma_f32_16x16x32_bf16 v[180:183], v[248:251], v[228:231], v[180:183]
  ds_read_b128 v[216:219], v22 offset:20480
  v_mfma_f32_16x16x32_bf16 v[184:187], v[248:251], v[232:235], v[184:187]
  ds_read_b128 v[220:223], v22 offset:22528
  v_mfma_f32_16x16x32_bf16 v[188:191], v[248:251], v[236:239], v[188:191]
  s_waitcnt lgkmcnt(6)
  v_mfma_f32_16x16x32_bf16 v[192:195], v[252:255], v[224:227], v[192:195]
  ds_read_b64_tr_b16 v[248:249], v26 offset:33280
  v_mfma_f32_16x16x32_bf16 v[196:199], v[252:255], v[228:231], v[196:199]
  ds_read_b64_tr_b16 v[250:251], v26 offset:34048
  v_mfma_f32_16x16x32_bf16 v[200:203], v[252:255], v[232:235], v[200:203]
  v_mfma_f32_16x16x32_bf16 v[204:207], v[252:255], v[236:239], v[204:207]
  s_waitcnt lgkmcnt(2)
  v_mfma_f32_16x16x32_bf16 v[48:51], v[208:211], v[240:243], v[48:51]
  ds_read_b64_tr_b16 v[252:253], v26 offset:39552
  v_mfma_f32_16x16x32_bf16 v[52:55], v[212:215], v[240:243], v[52:55]
  ds_read_b64_tr_b16 v[254:255], v26 offset:40320
  v_mfma_f32_16x16x32_bf16 v[56:59], v[216:219], v[240:243], v[56:59]
  v_mfma_f32_16x16x32_bf16 v[60:63], v[220:223], v[240:243], v[60:63]
  s_waitcnt lgkmcnt(6)
  v_mfma_f32_16x16x32_bf16 v[64:67], v[208:211], v[244:247], v[64:67]
  ds_read_b64_tr_b16 v[240:241], v26 offset:33312
  v_mfma_f32_16x16x32_bf16 v[68:71], v[212:215], v[244:247], v[68:71]
  ds_read_b64_tr_b16 v[242:243], v26 offset:34080
  v_mfma_f32_16x16x32_bf16 v[72:75], v[216:219], v[244:247], v[72:75]
  v_mfma_f32_16x16x32_bf16 v[76:79], v[220:223], v[244:247], v[76:79]
  s_waitcnt lgkmcnt(4)
  v_mfma_f32_16x16x32_bf16 v[112:115], v[248:251], v[208:211], v[112:115]
  ds_read_b64_tr_b16 v[244:245], v26 offset:39584
  v_mfma_f32_16x16x32_bf16 v[116:119], v[248:251], v[212:215], v[116:119]
  ds_read_b64_tr_b16 v[246:247], v26 offset:40352
  v_mfma_f32_16x16x32_bf16 v[120:123], v[248:251], v[216:219], v[120:123]
  v_mfma_f32_16x16x32_bf16 v[124:127], v[248:251], v[220:223], v[124:127]
  s_waitcnt lgkmcnt(4)
  v_mfma_f32_16x16x32_bf16 v[128:131], v[252:255], v[208:211], v[128:131]
  ds_read_b64_tr_b16 v[248:249], v26 offset:33344
  v_mfma_f32_16x16x32_bf16 v[132:135], v[252:255], v[212:215], v[132:135]
  ds_read_b64_tr_b16 v[250:251], v26 offset:34112
  v_mfma_f32_16x16x32_bf16 v[136:139], v[252:255], v[216:219], v[136:139]
  v_mfma_f32_16x16x32_bf16 v[140:143], v[252:255], v[220:223], v[140:143]
  s_waitcnt lgkmcnt(4)
  v_mfma_f32_16x16x32_bf16 v[144:147], v[240:243], v[208:211], v[144:147]
  ds_read_b64_tr_b16 v[252:253], v26 offset:39616
  v_mfma_f32_16x16x32_bf16 v[148:151], v[240:243], v[212:215], v[148:151]
  ds_read_b64_tr_b16 v[254:255], v26 offset:40384
  v_mfma_f32_16x16x32_bf16 v[152:155], v[240:243], v[216:219], v[152:155]
  v_mfma_f32_16x16x32_bf16 v[156:159], v[240:243], v[220:223], v[156:159]
  s_waitcnt lgkmcnt(4)
  v_mfma_f32_16x16x32_bf16 v[160:163], v[244:247], v[208:211], v[160:163]
  ds_read_b128 v[240:243], v25 offset:33280
  v_mfma_f32_16x16x32_bf16 v[164:167], v[244:247], v[212:215], v[164:167]
  ds_read_b128 v[224:227], v23 offset:16384
  v_mfma_f32_16x16x32_bf16 v[168:171], v[244:247], v[216:219], v[168:171]
  ds_read_b128 v[228:231], v23 offset:18432
  v_mfma_f32_16x16x32_bf16 v[172:175], v[244:247], v[220:223], v[172:175]
  s_waitcnt lgkmcnt(5)
  v_mfma_f32_16x16x32_bf16 v[176:179], v[248:251], v[208:211], v[176:179]
  ds_read_b128 v[244:247], v25 offset:35328
  v_mfma_f32_16x16x32_bf16 v[180:183], v[248:251], v[212:215], v[180:183]
  ds_read_b128 v[232:235], v23 offset:20480
  v_mfma_f32_16x16x32_bf16 v[184:187], v[248:251], v[216:219], v[184:187]
  ds_read_b128 v[236:239], v23 offset:22528
  v_mfma_f32_16x16x32_bf16 v[188:191], v[248:251], v[220:223], v[188:191]
  s_waitcnt lgkmcnt(6)
  v_mfma_f32_16x16x32_bf16 v[192:195], v[252:255], v[208:211], v[192:195]
  ds_read_b64_tr_b16 v[248:249], v26 offset:36352
  v_mfma_f32_16x16x32_bf16 v[196:199], v[252:255], v[212:215], v[196:199]
  ds_read_b64_tr_b16 v[250:251], v26 offset:37120
  v_mfma_f32_16x16x32_bf16 v[200:203], v[252:255], v[216:219], v[200:203]
  v_mfma_f32_16x16x32_bf16 v[204:207], v[252:255], v[220:223], v[204:207]
  s_waitcnt lgkmcnt(2)
  v_mfma_f32_16x16x32_bf16 v[48:51], v[224:227], v[240:243], v[48:51]
  ds_read_b64_tr_b16 v[252:253], v26 offset:42624
  v_mfma_f32_16x16x32_bf16 v[52:55], v[228:231], v[240:243], v[52:55]
  ds_read_b64_tr_b16 v[254:255], v26 offset:43392
  v_mfma_f32_16x16x32_bf16 v[56:59], v[232:235], v[240:243], v[56:59]
  v_mfma_f32_16x16x32_bf16 v[60:63], v[236:239], v[240:243], v[60:63]
  s_waitcnt lgkmcnt(6)
  v_mfma_f32_16x16x32_bf16 v[64:67], v[224:227], v[244:247], v[64:67]
  ds_read_b64_tr_b16 v[240:241], v26 offset:36384
  v_mfma_f32_16x16x32_bf16 v[68:71], v[228:231], v[244:247], v[68:71]
  ds_read_b64_tr_b16 v[242:243], v26 offset:37152
  v_mfma_f32_16x16x32_bf16 v[72:75], v[232:235], v[244:247], v[72:75]
  v_mfma_f32_16x16x32_bf16 v[76:79], v[236:239], v[244:247], v[76:79]
  s_waitcnt lgkmcnt(4)
  v_mfma_f32_16x16x32_bf16 v[112:115], v[248:251], v[224:227], v[112:115]
  ds_read_b64_tr_b16 v[244:245], v26 offset:42656
  v_mfma_f32_16x16x32_bf16 v[116:119], v[248:251], v[228:231], v[116:119]
  ds_read_b64_tr_b16 v[246:247], v26 offset:43424
  v_mfma_f32_16x16x32_bf16 v[120:123], v[248:251], v[232:235], v[120:123]
  v_mfma_f32_16x16x32_bf16 v[124:127], v[248:251], v[236:239], v[124:127]
  s_waitcnt lgkmcnt(4)
  v_mfma_f32_16x16x32_bf16 v[128:131], v[252:255], v[224:227], v[128:131]
  ds_read_b64_tr_b16 v[248:249], v26 offset:36416
  v_mfma_f32_16x16x32_bf16 v[132:135], v[252:255], v[228:231], v[132:135]
  ds_read_b64_tr_b16 v[250:251], v26 offset:37184
  v_mfma_f32_16x16x32_bf16 v[136:139], v[252:255], v[232:235], v[136:139]
  v_mfma_f32_16x16x32_bf16 v[140:143], v[252:255], v[236:239], v[140:143]
  s_waitcnt lgkmcnt(4)
  v_mfma_f32_16x16x32_bf16 v[144:147], v[240:243], v[224:227], v[144:147]
  ds_read_b64_tr_b16 v[252:253], v26 offset:42688
  v_mfma_f32_16x16x32_bf16 v[148:151], v[240:243], v[228:231], v[148:151]
  ds_read_b64_tr_b16 v[254:255], v26 offset:43456
  v_mfma_f32_16x16x32_bf16 v[152:155], v[240:243], v[232:235], v[152:155]
  v_mfma_f32_16x16x32_bf16 v[156:159], v[240:243], v[236:239], v[156:159]
  s_waitcnt lgkmcnt(0)
  s_barrier
  v_mfma_f32_16x16x32_bf16 v[160:163], v[244:247], v[224:227], v[160:163]
  ds_read_b128 v[240:243], v24 offset:0
  v_mfma_f32_16x16x32_bf16 v[164:167], v[244:247], v[228:231], v[164:167]
  ds_read_b128 v[208:211], v22 offset:0
  v_mfma_f32_16x16x32_bf16 v[168:171], v[244:247], v[232:235], v[168:171]
  ds_read_b128 v[212:215], v22 offset:2048
  v_mfma_f32_16x16x32_bf16 v[172:175], v[244:247], v[236:239], v[172:175]
  s_waitcnt lgkmcnt(5)
  v_mfma_f32_16x16x32_bf16 v[176:179], v[248:251], v[224:227], v[176:179]
  ds_read_b128 v[244:247], v24 offset:2048
  v_mfma_f32_16x16x32_bf16 v[180:183], v[248:251], v[228:231], v[180:183]
  ds_read_b128 v[216:219], v22 offset:4096
  v_mfma_f32_16x16x32_bf16 v[184:187], v[248:251], v[232:235], v[184:187]
  ds_read_b128 v[220:223], v22 offset:6144
  v_mfma_f32_16x16x32_bf16 v[188:191], v[248:251], v[236:239], v[188:191]
  s_waitcnt lgkmcnt(6)
  v_mfma_f32_16x16x32_bf16 v[192:195], v[252:255], v[224:227], v[192:195]
  ds_read_b64_tr_b16 v[248:249], v26 offset:0
  v_mfma_f32_16x16x32_bf16 v[196:199], v[252:255], v[228:231], v[196:199]
  ds_read_b64_tr_b16 v[250:251], v26 offset:768
  v_mfma_f32_16x16x32_bf16 v[200:203], v[252:255], v[232:235], v[200:203]
  v_mfma_f32_16x16x32_bf16 v[204:207], v[252:255], v[236:239], v[204:207]
  s_waitcnt lgkmcnt(2)
  v_mfma_f32_16x16x32_bf16 v[48:51], v[208:211], v[240:243], v[48:51]
  ds_read_b64_tr_b16 v[252:253], v26 offset:6272
  v_mfma_f32_16x16x32_bf16 v[52:55], v[212:215], v[240:243], v[52:55]
  ds_read_b64_tr_b16 v[254:255], v26 offset:7040
  v_mfma_f32_16x16x32_bf16 v[56:59], v[216:219], v[240:243], v[56:59]
  v_mfma_f32_16x16x32_bf16 v[60:63], v[220:223], v[240:243], v[60:63]
  s_waitcnt lgkmcnt(6)
  v_mfma_f32_16x16x32_bf16 v[64:67], v[208:211], v[244:247], v[64:67]
  ds_read_b64_tr_b16 v[240:241], v26 offset:32
  v_mfma_f32_16x16x32_bf16 v[68:71], v[212:215], v[244:247], v[68:71]
  ds_read_b64_tr_b16 v[242:243], v26 offset:800
  v_mfma_f32_16x16x32_bf16 v[72:75], v[216:219], v[244:247], v[72:75]
  v_mfma_f32_16x16x32_bf16 v[76:79], v[220:223], v[244:247], v[76:79]
  s_waitcnt lgkmcnt(4)
  v_mfma_f32_16x16x32_bf16 v[112:115], v[248:251], v[208:211], v[112:115]
  ds_read_b64_tr_b16 v[244:245], v26 offset:6304
  v_mfma_f32_16x16x32_bf16 v[116:119], v[248:251], v[212:215], v[116:119]
  ds_read_b64_tr_b16 v[246:247], v26 offset:7072
  v_mfma_f32_16x16x32_bf16 v[120:123], v[248:251], v[216:219], v[120:123]
  v_mfma_f32_16x16x32_bf16 v[124:127], v[248:251], v[220:223], v[124:127]
  s_waitcnt lgkmcnt(4)
  v_mfma_f32_16x16x32_bf16 v[128:131], v[252:255], v[208:211], v[128:131]
  ds_read_b64_tr_b16 v[248:249], v26 offset:64
  v_mfma_f32_16x16x32_bf16 v[132:135], v[252:255], v[212:215], v[132:135]
  ds_read_b64_tr_b16 v[250:251], v26 offset:832
  v_mfma_f32_16x16x32_bf16 v[136:139], v[252:255], v[216:219], v[136:139]
  v_mfma_f32_16x16x32_bf16 v[140:143], v[252:255], v[220:223], v[140:143]
  s_waitcnt lgkmcnt(4)
  v_mfma_f32_16x16x32_bf16 v[144:147], v[240:243], v[208:211], v[144:147]
  ds_read_b64_tr_b16 v[252:253], v26 offset:6336
  v_mfma_f32_16x16x32_bf16 v[148:151], v[240:243], v[212:215], v[148:151]
  ds_read_b64_tr_b16 v[254:255], v26 offset:7104
  v_mfma_f32_16x16x32_bf16 v[152:155], v[240:243], v[216:219], v[152:155]
  v_mfma_f32_16x16x32_bf16 v[156:159], v[240:243], v[220:223], v[156:159]
  s_waitcnt lgkmcnt(4)
  v_mfma_f32_16x16x32_bf16 v[160:163], v[244:247], v[208:211], v[160:163]
  ds_read_b128 v[240:243], v25 offset:0
  v_mfma_f32_16x16x32_bf16 v[164:167], v[244:247], v[212:215], v[164:167]
  ds_read_b128 v[224:227], v23 offset:0
  v_mfma_f32_16x16x32_bf16 v[168:171], v[244:247], v[216:219], v[168:171]
  ds_read_b128 v[228:231], v23 offset:2048
  v_mfma_f32_16x16x32_bf16 v[172:175], v[244:247], v[220:223], v[172:175]
  s_waitcnt lgkmcnt(5)
  v_mfma_f32_16x16x32_bf16 v[176:179], v[248:251], v[208:211], v[176:179]
  ds_read_b128 v[244:247], v25 offset:2048
  v_mfma_f32_16x16x32_bf16 v[180:183], v[248:251], v[212:215], v[180:183]
  ds_read_b128 v[232:235], v23 offset:4096
  v_mfma_f32_16x16x32_bf16 v[184:187], v[248:251], v[216:219], v[184:187]
  ds_read_b128 v[236:239], v23 offset:6144
  v_mfma_f32_16x16x32_bf16 v[188:191], v[248:251], v[220:223], v[188:191]
  s_waitcnt lgkmcnt(6)
  v_mfma_f32_16x16x32_bf16 v[192:195], v[252:255], v[208:211], v[192:195]
  ds_read_b64_tr_b16 v[248:249], v26 offset:3072
  v_mfma_f32_16x16x32_bf16 v[196:199], v[252:255], v[212:215], v[196:199]
  ds_read_b64_tr_b16 v[250:251], v26 offset:3840
  v_mfma_f32_16x16x32_bf16 v[200:203], v[252:255], v[216:219], v[200:203]
  v_mfma_f32_16x16x32_bf16 v[204:207], v[252:255], v[220:223], v[204:207]
  s_waitcnt lgkmcnt(2)
  v_mfma_f32_16x16x32_bf16 v[48:51], v[224:227], v[240:243], v[48:51]
  ds_read_b64_tr_b16 v[252:253], v26 offset:9344
  v_mfma_f32_16x16x32_bf16 v[52:55], v[228:231], v[240:243], v[52:55]
  ds_read_b64_tr_b16 v[254:255], v26 offset:10112
  v_mfma_f32_16x16x32_bf16 v[56:59], v[232:235], v[240:243], v[56:59]
  v_mfma_f32_16x16x32_bf16 v[60:63], v[236:239], v[240:243], v[60:63]
  s_waitcnt lgkmcnt(6)
  v_mfma_f32_16x16x32_bf16 v[64:67], v[224:227], v[244:247], v[64:67]
  ds_read_b64_tr_b16 v[240:241], v26 offset:3104
  v_mfma_f32_16x16x32_bf16 v[68:71], v[228:231], v[244:247], v[68:71]
  ds_read_b64_tr_b16 v[242:243], v26 offset:3872
  v_mfma_f32_16x16x32_bf16 v[72:75], v[232:235], v[244:247], v[72:75]
  v_mfma_f32_16x16x32_bf16 v[76:79], v[236:239], v[244:247], v[76:79]
  s_waitcnt lgkmcnt(4)
  v_mfma_f32_16x16x32_bf16 v[112:115], v[248:251], v[224:227], v[112:115]
  ds_read_b64_tr_b16 v[244:245], v26 offset:9376
  v_mfma_f32_16x16x32_bf16 v[116:119], v[248:251], v[228:231], v[116:119]
  ds_read_b64_tr_b16 v[246:247], v26 offset:10144
  v_mfma_f32_16x16x32_bf16 v[120:123], v[248:251], v[232:235], v[120:123]
  v_mfma_f32_16x16x32_bf16 v[124:127], v[248:251], v[236:239], v[124:127]
  s_waitcnt lgkmcnt(4)
  v_mfma_f32_16x16x32_bf16 v[128:131], v[252:255], v[224:227], v[128:131]
  ds_read_b64_tr_b16 v[248:249], v26 offset:3136
  v_mfma_f32_16x16x32_bf16 v[132:135], v[252:255], v[228:231], v[132:135]
  ds_read_b64_tr_b16 v[250:251], v26 offset:3904
  v_mfma_f32_16x16x32_bf16 v[136:139], v[252:255], v[232:235], v[136:139]
  v_mfma_f32_16x16x32_bf16 v[140:143], v[252:255], v[236:239], v[140:143]
  s_waitcnt lgkmcnt(4)
  v_mfma_f32_16x16x32_bf16 v[144:147], v[240:243], v[224:227], v[144:147]
  ds_read_b64_tr_b16 v[252:253], v26 offset:9408
  v_mfma_f32_16x16x32_bf16 v[148:151], v[240:243], v[228:231], v[148:151]
  ds_read_b64_tr_b16 v[254:255], v26 offset:10176
  v_mfma_f32_16x16x32_bf16 v[152:155], v[240:243], v[232:235], v[152:155]
  v_mfma_f32_16x16x32_bf16 v[156:159], v[240:243], v[236:239], v[156:159]
  s_waitcnt lgkmcnt(0)
  s_barrier
  v_mfma_f32_16x16x32_bf16 v[160:163], v[244:247], v[224:227], v[160:163]
  ds_read_b128 v[240:243], v24 offset:16640
  v_mfma_f32_16x16x32_bf16 v[164:167], v[244:247], v[228:231], v[164:167]
  ds_read_b128 v[208:211], v22 offset:8192
  v_mfma_f32_16x16x32_bf16 v[168:171], v[244:247], v[232:235], v[168:171]
  ds_read_b128 v[212:215], v22 offset:10240
  v_mfma_f32_16x16x32_bf16 v[172:175], v[244:247], v[236:239], v[172:175]
  s_waitcnt lgkmcnt(5)
  v_mfma_f32_16x16x32_bf16 v[176:179], v[248:251], v[224:227], v[176:179]
  ds_read_b128 v[244:247], v24 offset:18688
  v_mfma_f32_16x16x32_bf16 v[180:183], v[248:251], v[228:231], v[180:183]
  ds_read_b128 v[216:219], v22 offset:12288
  v_mfma_f32_16x16x32_bf16 v[184:187], v[248:251], v[232:235], v[184:187]
  ds_read_b128 v[220:223], v22 offset:14336
  v_mfma_f32_16x16x32_bf16 v[188:191], v[248:251], v[236:239], v[188:191]
  s_waitcnt lgkmcnt(6)
  v_mfma_f32_16x16x32_bf16 v[192:195], v[252:255], v[224:227], v[192:195]
  ds_read_b64_tr_b16 v[248:249], v26 offset:16640
  v_mfma_f32_16x16x32_bf16 v[196:199], v[252:255], v[228:231], v[196:199]
  ds_read_b64_tr_b16 v[250:251], v26 offset:17408
  v_mfma_f32_16x16x32_bf16 v[200:203], v[252:255], v[232:235], v[200:203]
  v_mfma_f32_16x16x32_bf16 v[204:207], v[252:255], v[236:239], v[204:207]
  s_waitcnt lgkmcnt(2)
  v_mfma_f32_16x16x32_bf16 v[48:51], v[208:211], v[240:243], v[48:51]
  ds_read_b64_tr_b16 v[252:253], v26 offset:22912
  v_mfma_f32_16x16x32_bf16 v[52:55], v[212:215], v[240:243], v[52:55]
  ds_read_b64_tr_b16 v[254:255], v26 offset:23680
  v_mfma_f32_16x16x32_bf16 v[56:59], v[216:219], v[240:243], v[56:59]
  v_mfma_f32_16x16x32_bf16 v[60:63], v[220:223], v[240:243], v[60:63]
  s_waitcnt lgkmcnt(6)
  v_mfma_f32_16x16x32_bf16 v[64:67], v[208:211], v[244:247], v[64:67]
  ds_read_b64_tr_b16 v[240:241], v26 offset:16672
  v_mfma_f32_16x16x32_bf16 v[68:71], v[212:215], v[244:247], v[68:71]
  ds_read_b64_tr_b16 v[242:243], v26 offset:17440
  v_mfma_f32_16x16x32_bf16 v[72:75], v[216:219], v[244:247], v[72:75]
  v_mfma_f32_16x16x32_bf16 v[76:79], v[220:223], v[244:247], v[76:79]
  s_waitcnt lgkmcnt(4)
  v_mfma_f32_16x16x32_bf16 v[112:115], v[248:251], v[208:211], v[112:115]
  ds_read_b64_tr_b16 v[244:245], v26 offset:22944
  v_mfma_f32_16x16x32_bf16 v[116:119], v[248:251], v[212:215], v[116:119]
  ds_read_b64_tr_b16 v[246:247], v26 offset:23712
  v_mfma_f32_16x16x32_bf16 v[120:123], v[248:251], v[216:219], v[120:123]
  v_mfma_f32_16x16x32_bf16 v[124:127], v[248:251], v[220:223], v[124:127]
  s_waitcnt lgkmcnt(4)
  v_mfma_f32_16x16x32_bf16 v[128:131], v[252:255], v[208:211], v[128:131]
  ds_read_b64_tr_b16 v[248:249], v26 offset:16704
  v_mfma_f32_16x16x32_bf16 v[132:135], v[252:255], v[212:215], v[132:135]
  ds_read_b64_tr_b16 v[250:251], v26 offset:17472
  v_mfma_f32_16x16x32_bf16 v[136:139], v[252:255], v[216:219], v[136:139]
  v_mfma_f32_16x16x32_bf16 v[140:143], v[252:255], v[220:223], v[140:143]
  s_waitcnt lgkmcnt(4)
  v_mfma_f32_16x16x32_bf16 v[144:147], v[240:243], v[208:211], v[144:147]
  ds_read_b64_tr_b16 v[252:253], v26 offset:22976
  v_mfma_f32_16x16x32_bf16 v[148:151], v[240:243], v[212:215], v[148:151]
  ds_read_b64_tr_b16 v[254:255], v26 offset:23744
  v_mfma_f32_16x16x32_bf16 v[152:155], v[240:243], v[216:219], v[152:155]
  v_mfma_f32_16x16x32_bf16 v[156:159], v[240:243], v[220:223], v[156:159]
  s_waitcnt lgkmcnt(4)
  v_mfma_f32_16x16x32_bf16 v[160:163], v[244:247], v[208:211], v[160:163]
  ds_read_b128 v[240:243], v25 offset:16640
  v_mfma_f32_16x16x32_bf16 v[164:167], v[244:247], v[212:215], v[164:167]
  ds_read_b128 v[224:227], v23 offset:8192
  v_mfma_f32_16x16x32_bf16 v[168:171], v[244:247], v[216:219], v[168:171]
  ds_read_b128 v[228:231], v23 offset:10240
  v_mfma_f32_16x16x32_bf16 v[172:175], v[244:247], v[220:223], v[172:175]
  s_waitcnt lgkmcnt(5)
  v_mfma_f32_16x16x32_bf16 v[176:179], v[248:251], v[208:211], v[176:179]
  ds_read_b128 v[244:247], v25 offset:18688
  v_mfma_f32_16x16x32_bf16 v[180:183], v[248:251], v[212:215], v[180:183]
  ds_read_b128 v[232:235], v23 offset:12288
  v_mfma_f32_16x16x32_bf16 v[184:187], v[248:251], v[216:219], v[184:187]
  ds_read_b128 v[236:239], v23 offset:14336
  v_mfma_f32_16x16x32_bf16 v[188:191], v[248:251], v[220:223], v[188:191]
  s_waitcnt lgkmcnt(6)
  v_mfma_f32_16x16x32_bf16 v[192:195], v[252:255], v[208:211], v[192:195]
  ds_read_b64_tr_b16 v[248:249], v26 offset:19712
  v_mfma_f32_16x16x32_bf16 v[196:199], v[252:255], v[212:215], v[196:199]
  ds_read_b64_tr_b16 v[250:251], v26 offset:20480
  v_mfma_f32_16x16x32_bf16 v[200:203], v[252:255], v[216:219], v[200:203]
  v_mfma_f32_16x16x32_bf16 v[204:207], v[252:255], v[220:223], v[204:207]
  s_waitcnt lgkmcnt(2)
  v_mfma_f32_16x16x32_bf16 v[48:51], v[224:227], v[240:243], v[48:51]
  ds_read_b64_tr_b16 v[252:253], v26 offset:25984
  v_mfma_f32_16x16x32_bf16 v[52:55], v[228:231], v[240:243], v[52:55]
  ds_read_b64_tr_b16 v[254:255], v26 offset:26752
  v_mfma_f32_16x16x32_bf16 v[56:59], v[232:235], v[240:243], v[56:59]
  v_mfma_f32_16x16x32_bf16 v[60:63], v[236:239], v[240:243], v[60:63]
  s_waitcnt lgkmcnt(6)
  v_mfma_f32_16x16x32_bf16 v[64:67], v[224:227], v[244:247], v[64:67]
  ds_read_b64_tr_b16 v[240:241], v26 offset:19744
  v_mfma_f32_16x16x32_bf16 v[68:71], v[228:231], v[244:247], v[68:71]
  ds_read_b64_tr_b16 v[242:243], v26 offset:20512
  v_mfma_f32_16x16x32_bf16 v[72:75], v[232:235], v[244:247], v[72:75]
  v_mfma_f32_16x16x32_bf16 v[76:79], v[236:239], v[244:247], v[76:79]
  s_waitcnt lgkmcnt(4)
  v_mfma_f32_16x16x32_bf16 v[112:115], v[248:251], v[224:227], v[112:115]
  ds_read_b64_tr_b16 v[244:245], v26 offset:26016
  v_mfma_f32_16x16x32_bf16 v[116:119], v[248:251], v[228:231], v[116:119]
  ds_read_b64_tr_b16 v[246:247], v26 offset:26784
  v_mfma_f32_16x16x32_bf16 v[120:123], v[248:251], v[232:235], v[120:123]
  v_mfma_f32_16x16x32_bf16 v[124:127], v[248:251], v[236:239], v[124:127]
  s_waitcnt lgkmcnt(4)
  v_mfma_f32_16x16x32_bf16 v[128:131], v[252:255], v[224:227], v[128:131]
  ds_read_b64_tr_b16 v[248:249], v26 offset:19776
  v_mfma_f32_16x16x32_bf16 v[132:135], v[252:255], v[228:231], v[132:135]
  ds_read_b64_tr_b16 v[250:251], v26 offset:20544
  v_mfma_f32_16x16x32_bf16 v[136:139], v[252:255], v[232:235], v[136:139]
  v_mfma_f32_16x16x32_bf16 v[140:143], v[252:255], v[236:239], v[140:143]
  s_waitcnt lgkmcnt(4)
  v_mfma_f32_16x16x32_bf16 v[144:147], v[240:243], v[224:227], v[144:147]
  ds_read_b64_tr_b16 v[252:253], v26 offset:26048
  v_mfma_f32_16x16x32_bf16 v[148:151], v[240:243], v[228:231], v[148:151]
  ds_read_b64_tr_b16 v[254:255], v26 offset:26816
  v_mfma_f32_16x16x32_bf16 v[152:155], v[240:243], v[232:235], v[152:155]
  v_mfma_f32_16x16x32_bf16 v[156:159], v[240:243], v[236:239], v[156:159]
  s_waitcnt lgkmcnt(0)
  s_barrier
  v_mfma_f32_16x16x32_bf16 v[160:163], v[244:247], v[224:227], v[160:163]
  ds_read_b128 v[240:243], v24 offset:33280
  v_mfma_f32_16x16x32_bf16 v[164:167], v[244:247], v[228:231], v[164:167]
  ds_read_b128 v[208:211], v22 offset:16384
  v_mfma_f32_16x16x32_bf16 v[168:171], v[244:247], v[232:235], v[168:171]
  ds_read_b128 v[212:215], v22 offset:18432
  v_mfma_f32_16x16x32_bf16 v[172:175], v[244:247], v[236:239], v[172:175]
  s_waitcnt lgkmcnt(5)
  v_mfma_f32_16x16x32_bf16 v[176:179], v[248:251], v[224:227], v[176:179]
  ds_read_b128 v[244:247], v24 offset:35328
  v_mfma_f32_16x16x32_bf16 v[180:183], v[248:251], v[228:231], v[180:183]
  ds_read_b128 v[216:219], v22 offset:20480
  v_mfma_f32_16x16x32_bf16 v[184:187], v[248:251], v[232:235], v[184:187]
  ds_read_b128 v[220:223], v22 offset:22528
  v_mfma_f32_16x16x32_bf16 v[188:191], v[248:251], v[236:239], v[188:191]
  s_waitcnt lgkmcnt(6)
  v_mfma_f32_16x16x32_bf16 v[192:195], v[252:255], v[224:227], v[192:195]
  ds_read_b64_tr_b16 v[248:249], v26 offset:33280
  v_mfma_f32_16x16x32_bf16 v[196:199], v[252:255], v[228:231], v[196:199]
  ds_read_b64_tr_b16 v[250:251], v26 offset:34048
  v_mfma_f32_16x16x32_bf16 v[200:203], v[252:255], v[232:235], v[200:203]
  v_mfma_f32_16x16x32_bf16 v[204:207], v[252:255], v[236:239], v[204:207]
  s_waitcnt lgkmcnt(2)
  v_mfma_f32_16x16x32_bf16 v[48:51], v[208:211], v[240:243], v[48:51]
  ds_read_b64_tr_b16 v[252:253], v26 offset:39552
  v_mfma_f32_16x16x32_bf16 v[52:55], v[212:215], v[240:243], v[52:55]
  ds_read_b64_tr_b16 v[254:255], v26 offset:40320
  v_mfma_f32_16x16x32_bf16 v[56:59], v[216:219], v[240:243], v[56:59]
  v_mfma_f32_16x16x32_bf16 v[60:63], v[220:223], v[240:243], v[60:63]
  s_waitcnt lgkmcnt(6)
  v_mfma_f32_16x16x32_bf16 v[64:67], v[208:211], v[244:247], v[64:67]
  ds_read_b64_tr_b16 v[240:241], v26 offset:33312
  v_mfma_f32_16x16x32_bf16 v[68:71], v[212:215], v[244:247], v[68:71]
  ds_read_b64_tr_b16 v[242:243], v26 offset:34080
  v_mfma_f32_16x16x32_bf16 v[72:75], v[216:219], v[244:247], v[72:75]
  v_mfma_f32_16x16x32_bf16 v[76:79], v[220:223], v[244:247], v[76:79]
  s_waitcnt lgkmcnt(4)
  v_mfma_f32_16x16x32_bf16 v[112:115], v[248:251], v[208:211], v[112:115]
  ds_read_b64_tr_b16 v[244:245], v26 offset:39584
  v_mfma_f32_16x16x32_bf16 v[116:119], v[248:251], v[212:215], v[116:119]
  ds_read_b64_tr_b16 v[246:247], v26 offset:40352
  v_mfma_f32_16x16x32_bf16 v[120:123], v[248:251], v[216:219], v[120:123]
  v_mfma_f32_16x16x32_bf16 v[124:127], v[248:251], v[220:223], v[124:127]
  s_waitcnt lgkmcnt(4)
  v_mfma_f32_16x16x32_bf16 v[128:131], v[252:255], v[208:211], v[128:131]
  ds_read_b64_tr_b16 v[248:249], v26 offset:33344
  v_mfma_f32_16x16x32_bf16 v[132:135], v[252:255], v[212:215], v[132:135]
  ds_read_b64_tr_b16 v[250:251], v26 offset:34112
  v_mfma_f32_16x16x32_bf16 v[136:139], v[252:255], v[216:219], v[136:139]
  v_mfma_f32_16x16x32_bf16 v[140:143], v[252:255], v[220:223], v[140:143]
  s_waitcnt lgkmcnt(4)
  v_mfma_f32_16x16x32_bf16 v[144:147], v[240:243], v[208:211], v[144:147]
  ds_read_b64_tr_b16 v[252:253], v26 offset:39616
  v_mfma_f32_16x16x32_bf16 v[148:151], v[240:243], v[212:215], v[148:151]
  ds_read_b64_tr_b16 v[254:255], v26 offset:40384
  v_mfma_f32_16x16x32_bf16 v[152:155], v[240:243], v[216:219], v[152:155]
  v_mfma_f32_16x16x32_bf16 v[156:159], v[240:243], v[220:223], v[156:159]
  s_waitcnt lgkmcnt(4)
  v_mfma_f32_16x16x32_bf16 v[160:163], v[244:247], v[208:211], v[160:163]
  ds_read_b128 v[240:243], v25 offset:33280
  v_mfma_f32_16x16x32_bf16 v[164:167], v[244:247], v[212:215], v[164:167]
  ds_read_b128 v[224:227], v23 offset:16384
  v_mfma_f32_16x16x32_bf16 v[168:171], v[244:247], v[216:219], v[168:171]
  ds_read_b128 v[228:231], v23 offset:18432
  v_mfma_f32_16x16x32_bf16 v[172:175], v[244:247], v[220:223], v[172:175]
  s_waitcnt lgkmcnt(5)
  v_mfma_f32_16x16x32_bf16 v[176:179], v[248:251], v[208:211], v[176:179]
  ds_read_b128 v[244:247], v25 offset:35328
  v_mfma_f32_16x16x32_bf16 v[180:183], v[248:251], v[212:215], v[180:183]
  ds_read_b128 v[232:235], v23 offset:20480
  v_mfma_f32_16x16x32_bf16 v[184:187], v[248:251], v[216:219], v[184:187]
  ds_read_b128 v[236:239], v23 offset:22528
  v_mfma_f32_16x16x32_bf16 v[188:191], v[248:251], v[220:223], v[188:191]
  s_waitcnt lgkmcnt(6)
  v_mfma_f32_16x16x32_bf16 v[192:195], v[252:255], v[208:211], v[192:195]
  ds_read_b64_tr_b16 v[248:249], v26 offset:36352
  v_mfma_f32_16x16x32_bf16 v[196:199], v[252:255], v[212:215], v[196:199]
  ds_read_b64_tr_b16 v[250:251], v26 offset:37120
  v_mfma_f32_16x16x32_bf16 v[200:203], v[252:255], v[216:219], v[200:203]
  v_mfma_f32_16x16x32_bf16 v[204:207], v[252:255], v[220:223], v[204:207]
  s_waitcnt lgkmcnt(2)
  v_mfma_f32_16x16x32_bf16 v[48:51], v[224:227], v[240:243], v[48:51]
  ds_read_b64_tr_b16 v[252:253], v26 offset:42624
  v_mfma_f32_16x16x32_bf16 v[52:55], v[228:231], v[240:243], v[52:55]
  ds_read_b64_tr_b16 v[254:255], v26 offset:43392
  v_mfma_f32_16x16x32_bf16 v[56:59], v[232:235], v[240:243], v[56:59]
  v_mfma_f32_16x16x32_bf16 v[60:63], v[236:239], v[240:243], v[60:63]
  s_waitcnt lgkmcnt(6)
  v_mfma_f32_16x16x32_bf16 v[64:67], v[224:227], v[244:247], v[64:67]
  ds_read_b64_tr_b16 v[240:241], v26 offset:36384
  v_mfma_f32_16x16x32_bf16 v[68:71], v[228:231], v[244:247], v[68:71]
  ds_read_b64_tr_b16 v[242:243], v26 offset:37152
  v_mfma_f32_16x16x32_bf16 v[72:75], v[232:235], v[244:247], v[72:75]
  v_mfma_f32_16x16x32_bf16 v[76:79], v[236:239], v[244:247], v[76:79]
  s_waitcnt lgkmcnt(4)
  v_mfma_f32_16x16x32_bf16 v[112:115], v[248:251], v[224:227], v[112:115]
  ds_read_b64_tr_b16 v[244:245], v26 offset:42656
  v_mfma_f32_16x16x32_bf16 v[116:119], v[248:251], v[228:231], v[116:119]
  ds_read_b64_tr_b16 v[246:247], v26 offset:43424
  v_mfma_f32_16x16x32_bf16 v[120:123], v[248:251], v[232:235], v[120:123]
  v_mfma_f32_16x16x32_bf16 v[124:127], v[248:251], v[236:239], v[124:127]
  s_waitcnt lgkmcnt(4)
  v_mfma_f32_16x16x32_bf16 v[128:131], v[252:255], v[224:227], v[128:131]
  ds_read_b64_tr_b16 v[248:249], v26 offset:36416
  v_mfma_f32_16x16x32_bf16 v[132:135], v[252:255], v[228:231], v[132:135]
  ds_read_b64_tr_b16 v[250:251], v26 offset:37184
  v_mfma_f32_16x16x32_bf16 v[136:139], v[252:255], v[232:235], v[136:139]
  v_mfma_f32_16x16x32_bf16 v[140:143], v[252:255], v[236:239], v[140:143]
  s_waitcnt lgkmcnt(4)
  v_mfma_f32_16x16x32_bf16 v[144:147], v[240:243], v[224:227], v[144:147]
  ds_read_b64_tr_b16 v[252:253], v26 offset:42688
  v_mfma_f32_16x16x32_bf16 v[148:151], v[240:243], v[228:231], v[148:151]
  ds_read_b64_tr_b16 v[254:255], v26 offset:43456
  v_mfma_f32_16x16x32_bf16 v[152:155], v[240:243], v[232:235], v[152:155]
  v_mfma_f32_16x16x32_bf16 v[156:159], v[240:243], v[236:239], v[156:159]
  s_waitcnt lgkmcnt(0)
  s_barrier
  v_mfma_f32_16x16x32_bf16 v[160:163], v[244:247], v[224:227], v[160:163]
  ds_read_b128 v[240:243], v24 offset:0
  v_mfma_f32_16x16x32_bf16 v[164:167], v[244:247], v[228:231], v[164:167]
  ds_read_b128 v[208:211], v22 offset:0
  v_mfma_f32_16x16x32_bf16 v[168:171], v[244:247], v[232:235], v[168:171]
  ds_read_b128 v[212:215], v22 offset:2048
  v_mfma_f32_16x16x32_bf16 v[172:175], v[244:247], v[236:239], v[172:175]
  s_waitcnt lgkmcnt(5)
  v_mfma_f32_16x16x32_bf16 v[176:179], v[248:251], v[224:227], v[176:179]
  ds_read_b128 v[244:247], v24 offset:2048
  v_mfma_f32_16x16x32_bf16 v[180:183], v[248:251], v[228:231], v[180:183]
  ds_read_b128 v[216:219], v22 offset:4096
  v_mfma_f32_16x16x32_bf16 v[184:187], v[248:251], v[232:235], v[184:187]
  ds_read_b128 v[220:223], v22 offset:6144
  v_mfma_f32_16x16x32_bf16 v[188:191], v[248:251], v[236:239], v[188:191]
  s_waitcnt lgkmcnt(6)
  v_mfma_f32_16x16x32_bf16 v[192:195], v[252:255], v[224:227], v[192:195]
  ds_read_b64_tr_b16 v[248:249], v26 offset:0
  v_mfma_f32_16x16x32_bf16 v[196:199], v[252:255], v[228:231], v[196:199]
  ds_read_b64_tr_b16 v[250:251], v26 offset:768
  v_mfma_f32_16x16x32_bf16 v[200:203], v[252:255], v[232:235], v[200:203]
  v_mfma_f32_16x16x32_bf16 v[204:207], v[252:255], v[236:239], v[204:207]
  s_waitcnt lgkmcnt(2)
  v_mfma_f32_16x16x32_bf16 v[48:51], v[208:211], v[240:243], v[48:51]
  ds_read_b64_tr_b16 v[252:253], v26 offset:6272
  v_mfma_f32_16x16x32_bf16 v[52:55], v[212:215], v[240:243], v[52:55]
  ds_read_b64_tr_b16 v[254:255], v26 offset:7040
  v_mfma_f32_16x16x32_bf16 v[56:59], v[216:219], v[240:243], v[56:59]
  v_mfma_f32_16x16x32_bf16 v[60:63], v[220:223], v[240:243], v[60:63]
  s_waitcnt lgkmcnt(6)
  v_mfma_f32_16x16x32_bf16 v[64:67], v[208:211], v[244:247], v[64:67]
  ds_read_b64_tr_b16 v[240:241], v26 offset:32
  v_mfma_f32_16x16x32_bf16 v[68:71], v[212:215], v[244:247], v[68:71]
  ds_read_b64_tr_b16 v[242:243], v26 offset:800
  v_mfma_f32_16x16x32_bf16 v[72:75], v[216:219], v[244:247], v[72:75]
  v_mfma_f32_16x16x32_bf16 v[76:79], v[220:223], v[244:247], v[76:79]
  s_waitcnt lgkmcnt(4)
  v_mfma_f32_16x16x32_bf16 v[112:115], v[248:251], v[208:211], v[112:115]
  ds_read_b64_tr_b16 v[244:245], v26 offset:6304
  v_mfma_f32_16x16x32_bf16 v[116:119], v[248:251], v[212:215], v[116:119]
  ds_read_b64_tr_b16 v[246:247], v26 offset:7072
  v_mfma_f32_16x16x32_bf16 v[120:123], v[248:251], v[216:219], v[120:123]
  v_mfma_f32_16x16x32_bf16 v[124:127], v[248:251], v[220:223], v[124:127]
  s_waitcnt lgkmcnt(4)
  v_mfma_f32_16x16x32_bf16 v[128:131], v[252:255], v[208:211], v[128:131]
  ds_read_b64_tr_b16 v[248:249], v26 offset:64
  v_mfma_f32_16x16x32_bf16 v[132:135], v[252:255], v[212:215], v[132:135]
  ds_read_b64_tr_b16 v[250:251], v26 offset:832
  v_mfma_f32_16x16x32_bf16 v[136:139], v[252:255], v[216:219], v[136:139]
  v_mfma_f32_16x16x32_bf16 v[140:143], v[252:255], v[220:223], v[140:143]
  s_waitcnt lgkmcnt(4)
  v_mfma_f32_16x16x32_bf16 v[144:147], v[240:243], v[208:211], v[144:147]
  ds_read_b64_tr_b16 v[252:253], v26 offset:6336
  v_mfma_f32_16x16x32_bf16 v[148:151], v[240:243], v[212:215], v[148:151]
  ds_read_b64_tr_b16 v[254:255], v26 offset:7104
  v_mfma_f32_16x16x32_bf16 v[152:155], v[240:243], v[216:219], v[152:155]
  v_mfma_f32_16x16x32_bf16 v[156:159], v[240:243], v[220:223], v[156:159]
  s_waitcnt lgkmcnt(4)
  v_mfma_f32_16x16x32_bf16 v[160:163], v[244:247], v[208:211], v[160:163]
  ds_read_b128 v[240:243], v25 offset:0
  v_mfma_f32_16x16x32_bf16 v[164:167], v[244:247], v[212:215], v[164:167]
  ds_read_b128 v[224:227], v23 offset:0
  v_mfma_f32_16x16x32_bf16 v[168:171], v[244:247], v[216:219], v[168:171]
  ds_read_b128 v[228:231], v23 offset:2048
  v_mfma_f32_16x16x32_bf16 v[172:175], v[244:247], v[220:223], v[172:175]
  s_waitcnt lgkmcnt(5)
  v_mfma_f32_16x16x32_bf16 v[176:179], v[248:251], v[208:211], v[176:179]
  ds_read_b128 v[244:247], v25 offset:2048
  v_mfma_f32_16x16x32_bf16 v[180:183], v[248:251], v[212:215], v[180:183]
  ds_read_b128 v[232:235], v23 offset:4096
  v_mfma_f32_16x16x32_bf16 v[184:187], v[248:251], v[216:219], v[184:187]
  ds_read_b128 v[236:239], v23 offset:6144
  v_mfma_f32_16x16x32_bf16 v[188:191], v[248:251], v[220:223], v[188:191]
  s_waitcnt lgkmcnt(6)
  v_mfma_f32_16x16x32_bf16 v[192:195], v[252:255], v[208:211], v[192:195]
  ds_read_b64_tr_b16 v[248:249], v26 offset:3072
  v_mfma_f32_16x16x32_bf16 v[196:199], v[252:255], v[212:215], v[196:199]
  ds_read_b64_tr_b16 v[250:251], v26 offset:3840
  v_mfma_f32_16x16x32_bf16 v[200:203], v[252:255], v[216:219], v[200:203]
  v_mfma_f32_16x16x32_bf16 v[204:207], v[252:255], v[220:223], v[204:207]
  s_waitcnt lgkmcnt(2)
  v_mfma_f32_16x16x32_bf16 v[48:51], v[224:227], v[240:243], v[48:51]
  ds_read_b64_tr_b16 v[252:253], v26 offset:9344
  v_mfma_f32_16x16x32_bf16 v[52:55], v[228:231], v[240:243], v[52:55]
  ds_read_b64_tr_b16 v[254:255], v26 offset:10112
  v_mfma_f32_16x16x32_bf16 v[56:59], v[232:235], v[240:243], v[56:59]
  v_mfma_f32_16x16x32_bf16 v[60:63], v[236:239], v[240:243], v[60:63]
  s_waitcnt lgkmcnt(6)
  v_mfma_f32_16x16x32_bf16 v[64:67], v[224:227], v[244:247], v[64:67]
  ds_read_b64_tr_b16 v[240:241], v26 offset:3104
  v_mfma_f32_16x16x32_bf16 v[68:71], v[228:231], v[244:247], v[68:71]
  ds_read_b64_tr_b16 v[242:243], v26 offset:3872
  v_mfma_f32_16x16x32_bf16 v[72:75], v[232:235], v[244:247], v[72:75]
  v_mfma_f32_16x16x32_bf16 v[76:79], v[236:239], v[244:247], v[76:79]
  s_waitcnt lgkmcnt(4)
  v_mfma_f32_16x16x32_bf16 v[112:115], v[248:251], v[224:227], v[112:115]
  ds_read_b64_tr_b16 v[244:245], v26 offset:9376
  v_mfma_f32_16x16x32_bf16 v[116:119], v[248:251], v[228:231], v[116:119]
  ds_read_b64_tr_b16 v[246:247], v26 offset:10144
  v_mfma_f32_16x16x32_bf16 v[120:123], v[248:251], v[232:235], v[120:123]
  v_mfma_f32_16x16x32_bf16 v[124:127], v[248:251], v[236:239], v[124:127]
  s_waitcnt lgkmcnt(4)
  v_mfma_f32_16x16x32_bf16 v[128:131], v[252:255], v[224:227], v[128:131]
  ds_read_b64_tr_b16 v[248:249], v26 offset:3136
  v_mfma_f32_16x16x32_bf16 v[132:135], v[252:255], v[228:231], v[132:135]
  ds_read_b64_tr_b16 v[250:251], v26 offset:3904
  v_mfma_f32_16x16x32_bf16 v[136:139], v[252:255], v[232:235], v[136:139]
  v_mfma_f32_16x16x32_bf16 v[140:143], v[252:255], v[236:239], v[140:143]
  s_waitcnt lgkmcnt(4)
  v_mfma_f32_16x16x32_bf16 v[144:147], v[240:243], v[224:227], v[144:147]
  ds_read_b64_tr_b16 v[252:253], v26 offset:9408
  v_mfma_f32_16x16x32_bf16 v[148:151], v[240:243], v[228:231], v[148:151]
  ds_read_b64_tr_b16 v[254:255], v26 offset:10176
  v_mfma_f32_16x16x32_bf16 v[152:155], v[240:243], v[232:235], v[152:155]
  v_mfma_f32_16x16x32_bf16 v[156:159], v[240:243], v[236:239], v[156:159]
  s_waitcnt lgkmcnt(0)
  s_barrier
  v_mfma_f32_16x16x32_bf16 v[160:163], v[244:247], v[224:227], v[160:163]
  ds_read_b128 v[240:243], v24 offset:16640
  v_mfma_f32_16x16x32_bf16 v[164:167], v[244:247], v[228:231], v[164:167]
  ds_read_b128 v[208:211], v22 offset:8192
  v_mfma_f32_16x16x32_bf16 v[168:171], v[244:247], v[232:235], v[168:171]
  ds_read_b128 v[212:215], v22 offset:10240
  v_mfma_f32_16x16x32_bf16 v[172:175], v[244:247], v[236:239], v[172:175]
  s_waitcnt lgkmcnt(5)
  v_mfma_f32_16x16x32_bf16 v[176:179], v[248:251], v[224:227], v[176:179]
  ds_read_b128 v[244:247], v24 offset:18688
  v_mfma_f32_16x16x32_bf16 v[180:183], v[248:251], v[228:231], v[180:183]
  ds_read_b128 v[216:219], v22 offset:12288
  v_mfma_f32_16x16x32_bf16 v[184:187], v[248:251], v[232:235], v[184:187]
  ds_read_b128 v[220:223], v22 offset:14336
  v_mfma_f32_16x16x32_bf16 v[188:191], v[248:251], v[236:239], v[188:191]
  s_waitcnt lgkmcnt(6)
  v_mfma_f32_16x16x32_bf16 v[192:195], v[252:255], v[224:227], v[192:195]
  ds_read_b64_tr_b16 v[248:249], v26 offset:16640
  v_mfma_f32_16x16x32_bf16 v[196:199], v[252:255], v[228:231], v[196:199]
  ds_read_b64_tr_b16 v[250:251], v26 offset:17408
  v_mfma_f32_16x16x32_bf16 v[200:203], v[252:255], v[232:235], v[200:203]
  v_mfma_f32_16x16x32_bf16 v[204:207], v[252:255], v[236:239], v[204:207]
  s_waitcnt lgkmcnt(2)
  v_mfma_f32_16x16x32_bf16 v[48:51], v[208:211], v[240:243], v[48:51]
  ds_read_b64_tr_b16 v[252:253], v26 offset:22912
  v_mfma_f32_16x16x32_bf16 v[52:55], v[212:215], v[240:243], v[52:55]
  ds_read_b64_tr_b16 v[254:255], v26 offset:23680
  v_mfma_f32_16x16x32_bf16 v[56:59], v[216:219], v[240:243], v[56:59]
  v_mfma_f32_16x16x32_bf16 v[60:63], v[220:223], v[240:243], v[60:63]
  s_waitcnt lgkmcnt(6)
  v_mfma_f32_16x16x32_bf16 v[64:67], v[208:211], v[244:247], v[64:67]
  ds_read_b64_tr_b16 v[240:241], v26 offset:16672
  v_mfma_f32_16x16x32_bf16 v[68:71], v[212:215], v[244:247], v[68:71]
  ds_read_b64_tr_b16 v[242:243], v26 offset:17440
  v_mfma_f32_16x16x32_bf16 v[72:75], v[216:219], v[244:247], v[72:75]
  v_mfma_f32_16x16x32_bf16 v[76:79], v[220:223], v[244:247], v[76:79]
  s_waitcnt lgkmcnt(4)
  v_mfma_f32_16x16x32_bf16 v[112:115], v[248:251], v[208:211], v[112:115]
  ds_read_b64_tr_b16 v[244:245], v26 offset:22944
  v_mfma_f32_16x16x32_bf16 v[116:119], v[248:251], v[212:215], v[116:119]
  ds_read_b64_tr_b16 v[246:247], v26 offset:23712
  v_mfma_f32_16x16x32_bf16 v[120:123], v[248:251], v[216:219], v[120:123]
  v_mfma_f32_16x16x32_bf16 v[124:127], v[248:251], v[220:223], v[124:127]
  s_waitcnt lgkmcnt(4)
  v_mfma_f32_16x16x32_bf16 v[128:131], v[252:255], v[208:211], v[128:131]
  ds_read_b64_tr_b16 v[248:249], v26 offset:16704
  v_mfma_f32_16x16x32_bf16 v[132:135], v[252:255], v[212:215], v[132:135]
  ds_read_b64_tr_b16 v[250:251], v26 offset:17472
  v_mfma_f32_16x16x32_bf16 v[136:139], v[252:255], v[216:219], v[136:139]
  v_mfma_f32_16x16x32_bf16 v[140:143], v[252:255], v[220:223], v[140:143]
  s_waitcnt lgkmcnt(4)
  v_mfma_f32_16x16x32_bf16 v[144:147], v[240:243], v[208:211], v[144:147]
  ds_read_b64_tr_b16 v[252:253], v26 offset:22976
  v_mfma_f32_16x16x32_bf16 v[148:151], v[240:243], v[212:215], v[148:151]
  ds_read_b64_tr_b16 v[254:255], v26 offset:23744
  v_mfma_f32_16x16x32_bf16 v[152:155], v[240:243], v[216:219], v[152:155]
  v_mfma_f32_16x16x32_bf16 v[156:159], v[240:243], v[220:223], v[156:159]
  s_waitcnt lgkmcnt(4)
  v_mfma_f32_16x16x32_bf16 v[160:163], v[244:247], v[208:211], v[160:163]
  ds_read_b128 v[240:243], v25 offset:16640
  v_mfma_f32_16x16x32_bf16 v[164:167], v[244:247], v[212:215], v[164:167]
  ds_read_b128 v[224:227], v23 offset:8192
  v_mfma_f32_16x16x32_bf16 v[168:171], v[244:247], v[216:219], v[168:171]
  ds_read_b128 v[228:231], v23 offset:10240
  v_mfma_f32_16x16x32_bf16 v[172:175], v[244:247], v[220:223], v[172:175]
  s_waitcnt lgkmcnt(5)
  v_mfma_f32_16x16x32_bf16 v[176:179], v[248:251], v[208:211], v[176:179]
  ds_read_b128 v[244:247], v25 offset:18688
  v_mfma_f32_16x16x32_bf16 v[180:183], v[248:251], v[212:215], v[180:183]
  ds_read_b128 v[232:235], v23 offset:12288
  v_mfma_f32_16x16x32_bf16 v[184:187], v[248:251], v[216:219], v[184:187]
  ds_read_b128 v[236:239], v23 offset:14336
  v_mfma_f32_16x16x32_bf16 v[188:191], v[248:251], v[220:223], v[188:191]
  s_waitcnt lgkmcnt(6)
  v_mfma_f32_16x16x32_bf16 v[192:195], v[252:255], v[208:211], v[192:195]
  ds_read_b64_tr_b16 v[248:249], v26 offset:19712
  v_mfma_f32_16x16x32_bf16 v[196:199], v[252:255], v[212:215], v[196:199]
  ds_read_b64_tr_b16 v[250:251], v26 offset:20480
  v_mfma_f32_16x16x32_bf16 v[200:203], v[252:255], v[216:219], v[200:203]
  v_mfma_f32_16x16x32_bf16 v[204:207], v[252:255], v[220:223], v[204:207]
  s_waitcnt lgkmcnt(2)
  v_mfma_f32_16x16x32_bf16 v[48:51], v[224:227], v[240:243], v[48:51]
  ds_read_b64_tr_b16 v[252:253], v26 offset:25984
  v_mfma_f32_16x16x32_bf16 v[52:55], v[228:231], v[240:243], v[52:55]
  ds_read_b64_tr_b16 v[254:255], v26 offset:26752
  v_mfma_f32_16x16x32_bf16 v[56:59], v[232:235], v[240:243], v[56:59]
  v_mfma_f32_16x16x32_bf16 v[60:63], v[236:239], v[240:243], v[60:63]
  s_waitcnt lgkmcnt(6)
  v_mfma_f32_16x16x32_bf16 v[64:67], v[224:227], v[244:247], v[64:67]
  ds_read_b64_tr_b16 v[240:241], v26 offset:19744
  v_mfma_f32_16x16x32_bf16 v[68:71], v[228:231], v[244:247], v[68:71]
  ds_read_b64_tr_b16 v[242:243], v26 offset:20512
  v_mfma_f32_16x16x32_bf16 v[72:75], v[232:235], v[244:247], v[72:75]
  ds_read_b128 v[208:211], v29 offset:0
  v_mfma_f32_16x16x32_bf16 v[76:79], v[236:239], v[244:247], v[76:79]
  ds_read_b128 v[212:215], v29 offset:16
  s_waitcnt lgkmcnt(6)
  v_mfma_f32_16x16x32_bf16 v[112:115], v[248:251], v[224:227], v[112:115]
  ds_read_b64_tr_b16 v[244:245], v26 offset:26016
  v_mfma_f32_16x16x32_bf16 v[116:119], v[248:251], v[228:231], v[116:119]
  ds_read_b64_tr_b16 v[246:247], v26 offset:26784
  v_mfma_f32_16x16x32_bf16 v[120:123], v[248:251], v[232:235], v[120:123]
  ds_read_b128 v[216:219], v29 offset:32
  v_mfma_f32_16x16x32_bf16 v[124:127], v[248:251], v[236:239], v[124:127]
  ds_read_b128 v[220:223], v29 offset:48
  s_waitcnt lgkmcnt(8)
  v_mfma_f32_16x16x32_bf16 v[128:131], v[252:255], v[224:227], v[128:131]
  ds_read_b64_tr_b16 v[248:249], v26 offset:19776
  v_mfma_f32_16x16x32_bf16 v[132:135], v[252:255], v[228:231], v[132:135]
  ds_read_b64_tr_b16 v[250:251], v26 offset:20544
  v_mfma_f32_16x16x32_bf16 v[136:139], v[252:255], v[232:235], v[136:139]
  v_mfma_f32_16x16x32_bf16 v[140:143], v[252:255], v[236:239], v[140:143]
  s_waitcnt lgkmcnt(8)
  v_mfma_f32_16x16x32_bf16 v[144:147], v[240:243], v[224:227], v[144:147]
  ds_read_b64_tr_b16 v[252:253], v26 offset:26048
  v_mfma_f32_16x16x32_bf16 v[148:151], v[240:243], v[228:231], v[148:151]
  ds_read_b64_tr_b16 v[254:255], v26 offset:26816
  v_mfma_f32_16x16x32_bf16 v[152:155], v[240:243], v[232:235], v[152:155]
  v_mfma_f32_16x16x32_bf16 v[156:159], v[240:243], v[236:239], v[156:159]
  s_waitcnt lgkmcnt(0)
  s_barrier
  v_mfma_f32_16x16x32_bf16 v[160:163], v[244:247], v[224:227], v[160:163]
  ds_read_b32 v12, v30 offset:0
  v_mfma_f32_16x16x32_bf16 v[164:167], v[244:247], v[228:231], v[164:167]
  ds_read_b32 v13, v30 offset:64
  v_mfma_f32_16x16x32_bf16 v[168:171], v[244:247], v[232:235], v[168:171]
  v_mfma_f32_16x16x32_bf16 v[172:175], v[244:247], v[236:239], v[172:175]
  v_mfma_f32_16x16x32_bf16 v[176:179], v[248:251], v[224:227], v[176:179]
  ds_read_b128 v[240:243], v29 offset:256
  v_mfma_f32_16x16x32_bf16 v[180:183], v[248:251], v[228:231], v[180:183]
  ds_read_b128 v[244:247], v29 offset:272
  v_mfma_f32_16x16x32_bf16 v[184:187], v[248:251], v[232:235], v[184:187]
  v_mfma_f32_16x16x32_bf16 v[188:191], v[248:251], v[236:239], v[188:191]
  v_mfma_f32_16x16x32_bf16 v[192:195], v[252:255], v[224:227], v[192:195]
  v_mfma_f32_16x16x32_bf16 v[196:199], v[252:255], v[228:231], v[196:199]
  ds_read_b128 v[248:251], v29 offset:288
  v_mfma_f32_16x16x32_bf16 v[200:203], v[252:255], v[232:235], v[200:203]
  v_mfma_f32_16x16x32_bf16 v[204:207], v[252:255], v[236:239], v[204:207]
  s_nop 1
  ds_read_b128 v[252:255], v29 offset:304
  v_pk_mul_f32 v[48:49], v[48:49], v[208:209]
  v_pk_mul_f32 v[64:65], v[64:65], v[208:209]
  v_pk_mul_f32 v[50:51], v[50:51], v[210:211]
  v_pk_mul_f32 v[66:67], v[66:67], v[210:211]
  v_pk_mul_f32 v[52:53], v[52:53], v[212:213]
  v_pk_mul_f32 v[68:69], v[68:69], v[212:213]
  v_pk_mul_f32 v[54:55], v[54:55], v[214:215]
  v_pk_mul_f32 v[70:71], v[70:71], v[214:215]
  v_pk_mul_f32 v[56:57], v[56:57], v[216:217]
  v_pk_mul_f32 v[72:73], v[72:73], v[216:217]
  v_pk_mul_f32 v[58:59], v[58:59], v[218:219]
  v_pk_mul_f32 v[74:75], v[74:75], v[218:219]
  v_pk_mul_f32 v[60:61], v[60:61], v[220:221]
  v_pk_mul_f32 v[76:77], v[76:77], v[220:221]
  v_pk_mul_f32 v[62:63], v[62:63], v[222:223]
  v_pk_mul_f32 v[78:79], v[78:79], v[222:223]
  s_waitcnt lgkmcnt(0)
  v_pk_fma_f32 v[48:49], v[240:241], v[12:13], v[48:49] op_sel_hi:[1,0,1]
  v_pk_fma_f32 v[64:65], v[12:13], v[240:241], v[64:65] op_sel:[1,0,0] op_sel_hi:[1,1,1]
  v_pk_fma_f32 v[50:51], v[242:243], v[12:13], v[50:51] op_sel_hi:[1,0,1]
  v_pk_fma_f32 v[66:67], v[12:13], v[242:243], v[66:67] op_sel:[1,0,0] op_sel_hi:[1,1,1]
  v_pk_fma_f32 v[52:53], v[244:245], v[12:13], v[52:53] op_sel_hi:[1,0,1]
  v_pk_fma_f32 v[68:69], v[12:13], v[244:245], v[68:69] op_sel:[1,0,0] op_sel_hi:[1,1,1]
  v_pk_fma_f32 v[54:55], v[246:247], v[12:13], v[54:55] op_sel_hi:[1,0,1]
  v_pk_fma_f32 v[70:71], v[12:13], v[246:247], v[70:71] op_sel:[1,0,0] op_sel_hi:[1,1,1]
  v_pk_fma_f32 v[56:57], v[248:249], v[12:13], v[56:57] op_sel_hi:[1,0,1]
  v_pk_fma_f32 v[72:73], v[12:13], v[248:249], v[72:73] op_sel:[1,0,0] op_sel_hi:[1,1,1]
  v_pk_fma_f32 v[58:59], v[250:251], v[12:13], v[58:59] op_sel_hi:[1,0,1]
  v_pk_fma_f32 v[74:75], v[12:13], v[250:251], v[74:75] op_sel:[1,0,0] op_sel_hi:[1,1,1]
  v_pk_fma_f32 v[60:61], v[252:253], v[12:13], v[60:61] op_sel_hi:[1,0,1]
  v_pk_fma_f32 v[76:77], v[12:13], v[252:253], v[76:77] op_sel:[1,0,0] op_sel_hi:[1,1,1]
  v_pk_fma_f32 v[62:63], v[254:255], v[12:13], v[62:63] op_sel_hi:[1,0,1]
  v_pk_fma_f32 v[78:79], v[12:13], v[254:255], v[78:79] op_sel:[1,0,0] op_sel_hi:[1,1,1]
  v_fmac_f32 v49, v80, v48
  v_fmac_f32 v65, v80, v64
  v_fmac_f32 v49, v47, v64
  v_fmac_f32 v65, v96, v48
  v_fmac_f32 v50, v80, v49
  v_fmac_f32 v66, v80, v65
  v_fmac_f32 v50, v47, v65
  v_fmac_f32 v66, v96, v49
  v_fmac_f32 v51, v80, v50
  v_fmac_f32 v67, v80, v66
  v_fmac_f32 v51, v47, v66
  v_fmac_f32 v67, v96, v50
  v_fmac_f32 v52, v80, v51
  v_fmac_f32 v68, v80, v67
  v_fmac_f32 v52, v47, v67
  v_fmac_f32 v68, v96, v51
  v_fmac_f32 v53, v80, v52
  v_fmac_f32 v69, v80, v68
  v_fmac_f32 v53, v47, v68
  v_fmac_f32 v69, v96, v52
  v_fmac_f32 v54, v80, v53
  v_fmac_f32 v70, v80, v69
  v_fmac_f32 v54, v47, v69
  v_fmac_f32 v70, v96, v53
  v_fmac_f32 v55, v80, v54
  v_fmac_f32 v71, v80, v70
  v_fmac_f32 v55, v47, v70
  v_fmac_f32 v71, v96, v54
  v_fmac_f32 v56, v80, v55
  v_fmac_f32 v72, v80, v71
  v_fmac_f32 v56, v47, v71
  v_fmac_f32 v72, v96, v55
  v_fmac_f32 v57, v80, v56
  v_fmac_f32 v73, v80, v72
  v_fmac_f32 v57, v47, v72
  v_fmac_f32 v73, v96, v56
  v_fmac_f32 v58, v80, v57
  v_fmac_f32 v74, v80, v73
  v_fmac_f32 v58, v47, v73
  v_fmac_f32 v74, v96, v57
  v_fmac_f32 v59, v80, v58
  v_fmac_f32 v75, v80, v74
  v_fmac_f32 v59, v47, v74
  v_fmac_f32 v75, v96, v58
  v_fmac_f32 v60, v80, v59
  v_fmac_f32 v76, v80, v75
  v_fmac_f32 v60, v47, v75
  v_fmac_f32 v76, v96, v59
  v_fmac_f32 v61, v80, v60
  v_fmac_f32 v77, v80, v76
  v_fmac_f32 v61, v47, v76
  v_fmac_f32 v77, v96, v60
  v_fmac_f32 v62, v80, v61
  v_fmac_f32 v78, v80, v77
  v_fmac_f32 v62, v47, v77
  v_fmac_f32 v78, v96, v61
  v_fmac_f32 v63, v80, v62
  v_fmac_f32 v79, v80, v78
  v_fmac_f32 v63, v47, v78
  v_fmac_f32 v79, v96, v62
  v_mov_b32 v6, v63
  v_mov_b32 v7, v79
  v_mov_b32 v4, 0
  v_mov_b32 v5, 0
  ds_read_b128 v[224:227], v27 offset:0
  ds_read_b128 v[228:231], v27 offset:256
  v_permlane16_swap_b32 v4, v6
  v_permlane16_swap_b32 v5, v7
  v_fma_f32 v8, v95, v4, v63
  v_fma_f32 v9, v95, v5, v79
  v_fma_f32 v8, -v111, v5, v8
  v_fmac_f32 v9, v111, v4
  v_mov_b32 v10, v8
  v_mov_b32 v11, v9
  v_mov_b32 v6, 0
  v_mov_b32 v7, 0
  v_permlane16_swap_b32 v10, v8
  v_permlane16_swap_b32 v11, v9
  ds_read_b128 v[232:235], v27 offset:512
  v_permlane32_swap_b32 v6, v8
  v_permlane32_swap_b32 v7, v9
  v_fma_f32 v8, v38, v6, v8
  v_fma_f32 v9, v38, v7, v9
  v_fma_f32 v8, -v39, v7, v8
  v_fmac_f32 v9, v39, v6
  v_min_u32 v8, -2, v8
  v_min_u32 v9, -2, v9
  s_mov_b32 exec_lo, 0
  s_mov_b32 exec_hi, 0xffff0000
  buffer_store_dwordx2 v[8:9], v46, s[32:35], s89 offen sc1
  s_mov_b64 exec, -1
  ds_read_b128 v[236:239], v27 offset:768
  ds_read_b128 v[208:211], v28 offset:256
  ds_read_b128 v[212:215], v28 offset:320
  ds_read_b128 v[216:219], v28 offset:512
  ds_read_b128 v[220:223], v28 offset:576
  ds_read_b128 v[240:243], v28 offset:768
  ds_read_b128 v[244:247], v28 offset:832
  v_fma_f32 v4, v40, v6, v4
  v_fma_f32 v5, v40, v7, v5
  v_fma_f32 v4, -v41, v7, v4
  v_fmac_f32 v5, v41, v6
  v_mul_f32 v44, v42, v4
  v_mul_f32 v45, v42, v5
  v_fma_f32 v44, -v43, v5, v44
  v_fmac_f32 v45, v43, v4
  v_and_b32 v2, 48, v1
  v_lshl_add_u32 v46, v2, 6, v46
  s_add_u32 s89, s89, 248
  s_and_b32 s89, s89, 0xffffff00
  v_mov_b32 v2, 1
  v_mov_b32 v3, 0
  s_waitcnt lgkmcnt(0)
  v_pk_fma_f32 v[112:113], v[226:227], v[208:209], v[112:113] op_sel:[1,0,0] op_sel_hi:[1,1,1]
  v_pk_fma_f32 v[114:115], v[226:227], v[210:211], v[114:115] op_sel:[1,0,0] op_sel_hi:[1,1,1]
  v_pk_fma_f32 v[116:117], v[230:231], v[208:209], v[116:117] op_sel:[1,0,0] op_sel_hi:[1,1,1]
  v_pk_fma_f32 v[118:119], v[230:231], v[210:211], v[118:119] op_sel:[1,0,0] op_sel_hi:[1,1,1]
  v_pk_mul_f32 v[248:249], v[112:113], v[112:113]
  v_pk_mul_f32 v[250:251], v[114:115], v[114:115]
  v_pk_mul_f32 v[252:253], v[116:117], v[116:117]
  v_pk_mul_f32 v[254:255], v[118:119], v[118:119]
  v_pk_fma_f32 v[248:249], v[224:225], v[248:249], v[224:225] op_sel:[1,0,0] op_sel_hi:[1,1,0]
  v_pk_fma_f32 v[250:251], v[224:225], v[250:251], v[224:225] op_sel:[1,0,0] op_sel_hi:[1,1,0]
  v_pk_fma_f32 v[252:253], v[228:229], v[252:253], v[228:229] op_sel:[1,0,0] op_sel_hi:[1,1,0]
  v_pk_fma_f32 v[254:255], v[228:229], v[254:255], v[228:229] op_sel:[1,0,0] op_sel_hi:[1,1,0]
  v_pk_mul_f32 v[248:249], v[248:249], v[112:113]
  v_pk_mul_f32 v[250:251], v[250:251], v[114:115]
  v_pk_mul_f32 v[252:253], v[252:253], v[116:117]
  v_pk_mul_f32 v[254:255], v[254:255], v[118:119]
  v_exp_f32 v248, v248
  v_exp_f32 v249, v249
  v_exp_f32 v250, v250
  v_exp_f32 v251, v251
  v_exp_f32 v252, v252
  v_exp_f32 v253, v253
  v_exp_f32 v254, v254
  v_exp_f32 v255, v255
  v_pk_fma_f32 v[128:129], v[226:227], v[212:213], v[128:129] op_sel:[1,0,0] op_sel_hi:[1,1,1]
  v_pk_fma_f32 v[130:131], v[226:227], v[214:215], v[130:131] op_sel:[1,0,0] op_sel_hi:[1,1,1]
  v_pk_fma_f32 v[132:133], v[230:231], v[212:213], v[132:133] op_sel:[1,0,0] op_sel_hi:[1,1,1]
  v_pk_fma_f32 v[134:135], v[230:231], v[214:215], v[134:135] op_sel:[1,0,0] op_sel_hi:[1,1,1]
  v_pk_fma_f32 v[248:249], v[248:249], v[226:227], v[226:227] op_sel_hi:[1,0,0]
  v_pk_fma_f32 v[250:251], v[250:251], v[226:227], v[226:227] op_sel_hi:[1,0,0]
  v_pk_fma_f32 v[252:253], v[252:253], v[230:231], v[230:231] op_sel_hi:[1,0,0]
  v_pk_fma_f32 v[254:255], v[254:255], v[230:231], v[230:231] op_sel_hi:[1,0,0]
  v_rcp_f32 v248, v248
  v_rcp_f32 v249, v249
  v_rcp_f32 v250, v250
  v_rcp_f32 v251, v251
  v_rcp_f32 v252, v252
  v_rcp_f32 v253, v253
  v_rcp_f32 v254, v254
  v_rcp_f32 v255, v255
  v_pk_mul_f32 v[112:113], v[112:113], v[128:129]
  v_pk_mul_f32 v[114:115], v[114:115], v[130:131]
  v_pk_mul_f32 v[116:117], v[116:117], v[132:133]
  v_pk_mul_f32 v[118:119], v[118:119], v[134:135]
  v_pk_mul_f32 v[112:113], v[112:113], v[248:249]
  v_pk_mul_f32 v[114:115], v[114:115], v[250:251]
  v_pk_mul_f32 v[116:117], v[116:117], v[252:253]
  v_pk_mul_f32 v[118:119], v[118:119], v[254:255]
  v_cvt_pk_bf16_f32 v128, v112, v113
  v_cvt_pk_bf16_f32 v130, v116, v117
  v_cvt_pk_bf16_f32 v129, v114, v115
  v_cvt_pk_bf16_f32 v131, v118, v119
  s_add_u32 s91, s81, 0
  v_permlane16_swap_b32 v128, v130
  v_permlane16_swap_b32 v129, v131
  buffer_store_dwordx4 v[128:131], v15, s[12:15], s91 offen sc1
  v_pk_fma_f32 v[120:121], v[234:235], v[208:209], v[120:121] op_sel:[1,0,0] op_sel_hi:[1,1,1]
  v_pk_fma_f32 v[122:123], v[234:235], v[210:211], v[122:123] op_sel:[1,0,0] op_sel_hi:[1,1,1]
  v_pk_fma_f32 v[124:125], v[238:239], v[208:209], v[124:125] op_sel:[1,0,0] op_sel_hi:[1,1,1]
  v_pk_fma_f32 v[126:127], v[238:239], v[210:211], v[126:127] op_sel:[1,0,0] op_sel_hi:[1,1,1]
  v_pk_mul_f32 v[248:249], v[120:121], v[120:121]
  v_pk_mul_f32 v[250:251], v[122:123], v[122:123]
  v_pk_mul_f32 v[252:253], v[124:125], v[124:125]
  v_pk_mul_f32 v[254:255], v[126:127], v[126:127]
  v_pk_fma_f32 v[248:249], v[232:233], v[248:249], v[232:233] op_sel:[1,0,0] op_sel_hi:[1,1,0]
  v_pk_fma_f32 v[250:251], v[232:233], v[250:251], v[232:233] op_sel:[1,0,0] op_sel_hi:[1,1,0]
  v_pk_fma_f32 v[252:253], v[236:237], v[252:253], v[236:237] op_sel:[1,0,0] op_sel_hi:[1,1,0]
  v_pk_fma_f32 v[254:255], v[236:237], v[254:255], v[236:237] op_sel:[1,0,0] op_sel_hi:[1,1,0]
  v_pk_mul_f32 v[248:249], v[248:249], v[120:121]
  v_pk_mul_f32 v[250:251], v[250:251], v[122:123]
  v_pk_mul_f32 v[252:253], v[252:253], v[124:125]
  v_pk_mul_f32 v[254:255], v[254:255], v[126:127]
  v_exp_f32 v248, v248
  v_exp_f32 v249, v249
  v_exp_f32 v250, v250
  v_exp_f32 v251, v251
  v_exp_f32 v252, v252
  v_exp_f32 v253, v253
  v_exp_f32 v254, v254
  v_exp_f32 v255, v255
  v_pk_fma_f32 v[136:137], v[234:235], v[212:213], v[136:137] op_sel:[1,0,0] op_sel_hi:[1,1,1]
  v_pk_fma_f32 v[138:139], v[234:235], v[214:215], v[138:139] op_sel:[1,0,0] op_sel_hi:[1,1,1]
  v_pk_fma_f32 v[140:141], v[238:239], v[212:213], v[140:141] op_sel:[1,0,0] op_sel_hi:[1,1,1]
  v_pk_fma_f32 v[142:143], v[238:239], v[214:215], v[142:143] op_sel:[1,0,0] op_sel_hi:[1,1,1]
  v_pk_fma_f32 v[248:249], v[248:249], v[234:235], v[234:235] op_sel_hi:[1,0,0]
  v_pk_fma_f32 v[250:251], v[250:251], v[234:235], v[234:235] op_sel_hi:[1,0,0]
  v_pk_fma_f32 v[252:253], v[252:253], v[238:239], v[238:239] op_sel_hi:[1,0,0]
  v_pk_fma_f32 v[254:255], v[254:255], v[238:239], v[238:239] op_sel_hi:[1,0,0]
  v_rcp_f32 v248, v248
  v_rcp_f32 v249, v249
  v_rcp_f32 v250, v250
  v_rcp_f32 v251, v251
  v_rcp_f32 v252, v252
  v_rcp_f32 v253, v253
  v_rcp_f32 v254, v254
  v_rcp_f32 v255, v255
  v_pk_mul_f32 v[120:121], v[120:121], v[136:137]
  v_pk_mul_f32 v[122:123], v[122:123], v[138:139]
  v_pk_mul_f32 v[124:125], v[124:125], v[140:141]
  v_pk_mul_f32 v[126:127], v[126:127], v[142:143]
  v_pk_mul_f32 v[120:121], v[120:121], v[248:249]
  v_pk_mul_f32 v[122:123], v[122:123], v[250:251]
  v_pk_mul_f32 v[124:125], v[124:125], v[252:253]
  v_pk_mul_f32 v[126:127], v[126:127], v[254:255]
  v_cvt_pk_bf16_f32 v136, v120, v121
  v_cvt_pk_bf16_f32 v138, v124, v125
  v_cvt_pk_bf16_f32 v137, v122, v123
  v_cvt_pk_bf16_f32 v139, v126, v127
  s_add_u32 s91, s81, 153600
  v_permlane16_swap_b32 v136, v138
  v_permlane16_swap_b32 v137, v139
  buffer_store_dwordx4 v[136:139], v15, s[12:15], s91 offen sc1
  v_pk_fma_f32 v[144:145], v[226:227], v[216:217], v[144:145] op_sel:[1,0,0] op_sel_hi:[1,1,1]
  v_pk_fma_f32 v[146:147], v[226:227], v[218:219], v[146:147] op_sel:[1,0,0] op_sel_hi:[1,1,1]
  v_pk_fma_f32 v[148:149], v[230:231], v[216:217], v[148:149] op_sel:[1,0,0] op_sel_hi:[1,1,1]
  v_pk_fma_f32 v[150:151], v[230:231], v[218:219], v[150:151] op_sel:[1,0,0] op_sel_hi:[1,1,1]
  v_pk_mul_f32 v[248:249], v[144:145], v[144:145]
  v_pk_mul_f32 v[250:251], v[146:147], v[146:147]
  v_pk_mul_f32 v[252:253], v[148:149], v[148:149]
  v_pk_mul_f32 v[254:255], v[150:151], v[150:151]
  v_pk_fma_f32 v[248:249], v[224:225], v[248:249], v[224:225] op_sel:[1,0,0] op_sel_hi:[1,1,0]
  v_pk_fma_f32 v[250:251], v[224:225], v[250:251], v[224:225] op_sel:[1,0,0] op_sel_hi:[1,1,0]
  v_pk_fma_f32 v[252:253], v[228:229], v[252:253], v[228:229] op_sel:[1,0,0] op_sel_hi:[1,1,0]
  v_pk_fma_f32 v[254:255], v[228:229], v[254:255], v[228:229] op_sel:[1,0,0] op_sel_hi:[1,1,0]
  v_pk_mul_f32 v[248:249], v[248:249], v[144:145]
  v_pk_mul_f32 v[250:251], v[250:251], v[146:147]
  v_pk_mul_f32 v[252:253], v[252:253], v[148:149]
  v_pk_mul_f32 v[254:255], v[254:255], v[150:151]
  v_exp_f32 v248, v248
  v_exp_f32 v249, v249
  v_exp_f32 v250, v250
  v_exp_f32 v251, v251
  v_exp_f32 v252, v252
  v_exp_f32 v253, v253
  v_exp_f32 v254, v254
  v_exp_f32 v255, v255
  v_pk_fma_f32 v[160:161], v[226:227], v[220:221], v[160:161] op_sel:[1,0,0] op_sel_hi:[1,1,1]
  v_pk_fma_f32 v[162:163], v[226:227], v[222:223], v[162:163] op_sel:[1,0,0] op_sel_hi:[1,1,1]
  v_pk_fma_f32 v[164:165], v[230:231], v[220:221], v[164:165] op_sel:[1,0,0] op_sel_hi:[1,1,1]
  v_pk_fma_f32 v[166:167], v[230:231], v[222:223], v[166:167] op_sel:[1,0,0] op_sel_hi:[1,1,1]
  v_pk_fma_f32 v[248:249], v[248:249], v[226:227], v[226:227] op_sel_hi:[1,0,0]
  v_pk_fma_f32 v[250:251], v[250:251], v[226:227], v[226:227] op_sel_hi:[1,0,0]
  v_pk_fma_f32 v[252:253], v[252:253], v[230:231], v[230:231] op_sel_hi:[1,0,0]
  v_pk_fma_f32 v[254:255], v[254:255], v[230:231], v[230:231] op_sel_hi:[1,0,0]
  v_rcp_f32 v248, v248
  v_rcp_f32 v249, v249
  v_rcp_f32 v250, v250
  v_rcp_f32 v251, v251
  v_rcp_f32 v252, v252
  v_rcp_f32 v253, v253
  v_rcp_f32 v254, v254
  v_rcp_f32 v255, v255
  v_pk_mul_f32 v[144:145], v[144:145], v[160:161]
  v_pk_mul_f32 v[146:147], v[146:147], v[162:163]
  v_pk_mul_f32 v[148:149], v[148:149], v[164:165]
  v_pk_mul_f32 v[150:151], v[150:151], v[166:167]
  v_pk_mul_f32 v[144:145], v[144:145], v[248:249]
  v_pk_mul_f32 v[146:147], v[146:147], v[250:251]
  v_pk_mul_f32 v[148:149], v[148:149], v[252:253]
  v_pk_mul_f32 v[150:151], v[150:151], v[254:255]
  v_cvt_pk_bf16_f32 v160, v144, v145
  v_cvt_pk_bf16_f32 v162, v148, v149
  v_cvt_pk_bf16_f32 v161, v146, v147
  v_cvt_pk_bf16_f32 v163, v150, v151
  s_add_u32 s91, s82, 0
  v_permlane16_swap_b32 v160, v162
  v_permlane16_swap_b32 v161, v163
  buffer_store_dwordx4 v[160:163], v15, s[12:15], s91 offen sc1
  v_pk_fma_f32 v[152:153], v[234:235], v[216:217], v[152:153] op_sel:[1,0,0] op_sel_hi:[1,1,1]
  v_pk_fma_f32 v[154:155], v[234:235], v[218:219], v[154:155] op_sel:[1,0,0] op_sel_hi:[1,1,1]
  v_pk_fma_f32 v[156:157], v[238:239], v[216:217], v[156:157] op_sel:[1,0,0] op_sel_hi:[1,1,1]
  v_pk_fma_f32 v[158:159], v[238:239], v[218:219], v[158:159] op_sel:[1,0,0] op_sel_hi:[1,1,1]
  v_pk_mul_f32 v[248:249], v[152:153], v[152:153]
  v_pk_mul_f32 v[250:251], v[154:155], v[154:155]
  v_pk_mul_f32 v[252:253], v[156:157], v[156:157]
  v_pk_mul_f32 v[254:255], v[158:159], v[158:159]
  v_pk_fma_f32 v[248:249], v[232:233], v[248:249], v[232:233] op_sel:[1,0,0] op_sel_hi:[1,1,0]
  v_pk_fma_f32 v[250:251], v[232:233], v[250:251], v[232:233] op_sel:[1,0,0] op_sel_hi:[1,1,0]
  v_pk_fma_f32 v[252:253], v[236:237], v[252:253], v[236:237] op_sel:[1,0,0] op_sel_hi:[1,1,0]
  v_pk_fma_f32 v[254:255], v[236:237], v[254:255], v[236:237] op_sel:[1,0,0] op_sel_hi:[1,1,0]
  v_pk_mul_f32 v[248:249], v[248:249], v[152:153]
  v_pk_mul_f32 v[250:251], v[250:251], v[154:155]
  v_pk_mul_f32 v[252:253], v[252:253], v[156:157]
  v_pk_mul_f32 v[254:255], v[254:255], v[158:159]
  v_exp_f32 v248, v248
  v_exp_f32 v249, v249
  v_exp_f32 v250, v250
  v_exp_f32 v251, v251
  v_exp_f32 v252, v252
  v_exp_f32 v253, v253
  v_exp_f32 v254, v254
  v_exp_f32 v255, v255
  v_pk_fma_f32 v[168:169], v[234:235], v[220:221], v[168:169] op_sel:[1,0,0] op_sel_hi:[1,1,1]
  v_pk_fma_f32 v[170:171], v[234:235], v[222:223], v[170:171] op_sel:[1,0,0] op_sel_hi:[1,1,1]
  v_pk_fma_f32 v[172:173], v[238:239], v[220:221], v[172:173] op_sel:[1,0,0] op_sel_hi:[1,1,1]
  v_pk_fma_f32 v[174:175], v[238:239], v[222:223], v[174:175] op_sel:[1,0,0] op_sel_hi:[1,1,1]
  v_pk_fma_f32 v[248:249], v[248:249], v[234:235], v[234:235] op_sel_hi:[1,0,0]
  v_pk_fma_f32 v[250:251], v[250:251], v[234:235], v[234:235] op_sel_hi:[1,0,0]
  v_pk_fma_f32 v[252:253], v[252:253], v[238:239], v[238:239] op_sel_hi:[1,0,0]
  v_pk_fma_f32 v[254:255], v[254:255], v[238:239], v[238:239] op_sel_hi:[1,0,0]
  v_rcp_f32 v248, v248
  v_rcp_f32 v249, v249
  v_rcp_f32 v250, v250
  v_rcp_f32 v251, v251
  v_rcp_f32 v252, v252
  v_rcp_f32 v253, v253
  v_rcp_f32 v254, v254
  v_rcp_f32 v255, v255
  v_pk_mul_f32 v[152:153], v[152:153], v[168:169]
  v_pk_mul_f32 v[154:155], v[154:155], v[170:171]
  v_pk_mul_f32 v[156:157], v[156:157], v[172:173]
  v_pk_mul_f32 v[158:159], v[158:159], v[174:175]
  v_pk_mul_f32 v[152:153], v[152:153], v[248:249]
  v_pk_mul_f32 v[154:155], v[154:155], v[250:251]
  v_pk_mul_f32 v[156:157], v[156:157], v[252:253]
  v_pk_mul_f32 v[158:159], v[158:159], v[254:255]
  v_cvt_pk_bf16_f32 v168, v152, v153
  v_cvt_pk_bf16_f32 v170, v156, v157
  v_cvt_pk_bf16_f32 v169, v154, v155
  v_cvt_pk_bf16_f32 v171, v158, v159
  s_add_u32 s91, s82, 153600
  v_permlane16_swap_b32 v168, v170
  v_permlane16_swap_b32 v169, v171
  buffer_store_dwordx4 v[168:171], v15, s[12:15], s91 offen sc1
  v_pk_fma_f32 v[176:177], v[226:227], v[240:241], v[176:177] op_sel:[1,0,0] op_sel_hi:[1,1,1]
  v_pk_fma_f32 v[178:179], v[226:227], v[242:243], v[178:179] op_sel:[1,0,0] op_sel_hi:[1,1,1]
  v_pk_fma_f32 v[180:181], v[230:231], v[240:241], v[180:181] op_sel:[1,0,0] op_sel_hi:[1,1,1]
  v_pk_fma_f32 v[182:183], v[230:231], v[242:243], v[182:183] op_sel:[1,0,0] op_sel_hi:[1,1,1]
  v_pk_mul_f32 v[248:249], v[176:177], v[176:177]
  v_pk_mul_f32 v[250:251], v[178:179], v[178:179]
  v_pk_mul_f32 v[252:253], v[180:181], v[180:181]
  v_pk_mul_f32 v[254:255], v[182:183], v[182:183]
  v_pk_fma_f32 v[248:249], v[224:225], v[248:249], v[224:225] op_sel:[1,0,0] op_sel_hi:[1,1,0]
  v_pk_fma_f32 v[250:251], v[224:225], v[250:251], v[224:225] op_sel:[1,0,0] op_sel_hi:[1,1,0]
  v_pk_fma_f32 v[252:253], v[228:229], v[252:253], v[228:229] op_sel:[1,0,0] op_sel_hi:[1,1,0]
  v_pk_fma_f32 v[254:255], v[228:229], v[254:255], v[228:229] op_sel:[1,0,0] op_sel_hi:[1,1,0]
  v_pk_mul_f32 v[248:249], v[248:249], v[176:177]
  v_pk_mul_f32 v[250:251], v[250:251], v[178:179]
  v_pk_mul_f32 v[252:253], v[252:253], v[180:181]
  v_pk_mul_f32 v[254:255], v[254:255], v[182:183]
  v_exp_f32 v248, v248
  v_exp_f32 v249, v249
  v_exp_f32 v250, v250
  v_exp_f32 v251, v251
  v_exp_f32 v252, v252
  v_exp_f32 v253, v253
  v_exp_f32 v254, v254
  v_exp_f32 v255, v255
  v_pk_fma_f32 v[192:193], v[226:227], v[244:245], v[192:193] op_sel:[1,0,0] op_sel_hi:[1,1,1]
  v_pk_fma_f32 v[194:195], v[226:227], v[246:247], v[194:195] op_sel:[1,0,0] op_sel_hi:[1,1,1]
  v_pk_fma_f32 v[196:197], v[230:231], v[244:245], v[196:197] op_sel:[1,0,0] op_sel_hi:[1,1,1]
  v_pk_fma_f32 v[198:199], v[230:231], v[246:247], v[198:199] op_sel:[1,0,0] op_sel_hi:[1,1,1]
  v_pk_fma_f32 v[248:249], v[248:249], v[226:227], v[226:227] op_sel_hi:[1,0,0]
  v_pk_fma_f32 v[250:251], v[250:251], v[226:227], v[226:227] op_sel_hi:[1,0,0]
  v_pk_fma_f32 v[252:253], v[252:253], v[230:231], v[230:231] op_sel_hi:[1,0,0]
  v_pk_fma_f32 v[254:255], v[254:255], v[230:231], v[230:231] op_sel_hi:[1,0,0]
  v_rcp_f32 v248, v248
  v_rcp_f32 v249, v249
  v_rcp_f32 v250, v250
  v_rcp_f32 v251, v251
  v_rcp_f32 v252, v252
  v_rcp_f32 v253, v253
  v_rcp_f32 v254, v254
  v_rcp_f32 v255, v255
  v_pk_mul_f32 v[176:177], v[176:177], v[192:193]
  v_pk_mul_f32 v[178:179], v[178:179], v[194:195]
  v_pk_mul_f32 v[180:181], v[180:181], v[196:197]
  v_pk_mul_f32 v[182:183], v[182:183], v[198:199]
  v_pk_mul_f32 v[176:177], v[176:177], v[248:249]
  v_pk_mul_f32 v[178:179], v[178:179], v[250:251]
  v_pk_mul_f32 v[180:181], v[180:181], v[252:253]
  v_pk_mul_f32 v[182:183], v[182:183], v[254:255]
  v_cvt_pk_bf16_f32 v192, v176, v177
  v_cvt_pk_bf16_f32 v194, v180, v181
  v_cvt_pk_bf16_f32 v193, v178, v179
  v_cvt_pk_bf16_f32 v195, v182, v183
  s_add_u32 s91, s83, 0
  v_permlane16_swap_b32 v192, v194
  v_permlane16_swap_b32 v193, v195
  buffer_store_dwordx4 v[192:195], v15, s[12:15], s91 offen sc1
  buffer_load_dwordx4 v[144:147], v46, s[32:35], s89 offen offset:0 sc1
  buffer_load_dwordx4 v[148:151], v46, s[32:35], s89 offen offset:256 sc1
  buffer_load_dwordx4 v[152:155], v46, s[32:35], s89 offen offset:512 sc1
  buffer_load_dwordx4 v[156:159], v46, s[32:35], s89 offen offset:768 sc1
  v_pk_fma_f32 v[184:185], v[234:235], v[240:241], v[184:185] op_sel:[1,0,0] op_sel_hi:[1,1,1]
  v_pk_fma_f32 v[186:187], v[234:235], v[242:243], v[186:187] op_sel:[1,0,0] op_sel_hi:[1,1,1]
  v_pk_fma_f32 v[188:189], v[238:239], v[240:241], v[188:189] op_sel:[1,0,0] op_sel_hi:[1,1,1]
  v_pk_fma_f32 v[190:191], v[238:239], v[242:243], v[190:191] op_sel:[1,0,0] op_sel_hi:[1,1,1]
  v_pk_mul_f32 v[248:249], v[184:185], v[184:185]
  v_pk_mul_f32 v[250:251], v[186:187], v[186:187]
  v_pk_mul_f32 v[252:253], v[188:189], v[188:189]
  v_pk_mul_f32 v[254:255], v[190:191], v[190:191]
  v_pk_fma_f32 v[248:249], v[232:233], v[248:249], v[232:233] op_sel:[1,0,0] op_sel_hi:[1,1,0]
  v_pk_fma_f32 v[250:251], v[232:233], v[250:251], v[232:233] op_sel:[1,0,0] op_sel_hi:[1,1,0]
  v_pk_fma_f32 v[252:253], v[236:237], v[252:253], v[236:237] op_sel:[1,0,0] op_sel_hi:[1,1,0]
  v_pk_fma_f32 v[254:255], v[236:237], v[254:255], v[236:237] op_sel:[1,0,0] op_sel_hi:[1,1,0]
  v_pk_mul_f32 v[248:249], v[248:249], v[184:185]
  v_pk_mul_f32 v[250:251], v[250:251], v[186:187]
  v_pk_mul_f32 v[252:253], v[252:253], v[188:189]
  v_pk_mul_f32 v[254:255], v[254:255], v[190:191]
  v_exp_f32 v248, v248
  v_exp_f32 v249, v249
  v_exp_f32 v250, v250
  v_exp_f32 v251, v251
  v_exp_f32 v252, v252
  v_exp_f32 v253, v253
  v_exp_f32 v254, v254
  v_exp_f32 v255, v255
  v_pk_fma_f32 v[200:201], v[234:235], v[244:245], v[200:201] op_sel:[1,0,0] op_sel_hi:[1,1,1]
  v_pk_fma_f32 v[202:203], v[234:235], v[246:247], v[202:203] op_sel:[1,0,0] op_sel_hi:[1,1,1]
  v_pk_fma_f32 v[204:205], v[238:239], v[244:245], v[204:205] op_sel:[1,0,0] op_sel_hi:[1,1,1]
  v_pk_fma_f32 v[206:207], v[238:239], v[246:247], v[206:207] op_sel:[1,0,0] op_sel_hi:[1,1,1]
  v_pk_fma_f32 v[248:249], v[248:249], v[234:235], v[234:235] op_sel_hi:[1,0,0]
  v_pk_fma_f32 v[250:251], v[250:251], v[234:235], v[234:235] op_sel_hi:[1,0,0]
  v_pk_fma_f32 v[252:253], v[252:253], v[238:239], v[238:239] op_sel_hi:[1,0,0]
  v_pk_fma_f32 v[254:255], v[254:255], v[238:239], v[238:239] op_sel_hi:[1,0,0]
  v_rcp_f32 v248, v248
  v_rcp_f32 v249, v249
  v_rcp_f32 v250, v250
  v_rcp_f32 v251, v251
  v_rcp_f32 v252, v252
  v_rcp_f32 v253, v253
  v_rcp_f32 v254, v254
  v_rcp_f32 v255, v255
  v_pk_mul_f32 v[184:185], v[184:185], v[200:201]
  v_pk_mul_f32 v[186:187], v[186:187], v[202:203]
  v_pk_mul_f32 v[188:189], v[188:189], v[204:205]
  v_pk_mul_f32 v[190:191], v[190:191], v[206:207]
  v_pk_mul_f32 v[184:185], v[184:185], v[248:249]
  v_pk_mul_f32 v[186:187], v[186:187], v[250:251]
  v_pk_mul_f32 v[188:189], v[188:189], v[252:253]
  v_pk_mul_f32 v[190:191], v[190:191], v[254:255]
  v_cvt_pk_bf16_f32 v200, v184, v185
  v_cvt_pk_bf16_f32 v202, v188, v189
  v_cvt_pk_bf16_f32 v201, v186, v187
  v_cvt_pk_bf16_f32 v203, v190, v191
  s_add_u32 s91, s83, 153600
  v_permlane16_swap_b32 v200, v202
  v_permlane16_swap_b32 v201, v203
  buffer_store_dwordx4 v[200:203], v15, s[12:15], s91 offen sc1
  v_pk_mul_f32 v[4:5], v[42:43], v[48:49] op_sel:[1,0] op_sel_hi:[1,1] neg_lo:[0,1] neg_hi:[0,1]
  v_pk_mul_f32 v[48:49], v[48:49], v[42:43] op_sel_hi:[1,0]
  v_pk_fma_f32 v[48:49], v[42:43], v[64:65], v[48:49] op_sel:[1,0,0] op_sel_hi:[1,1,1] neg_lo:[0,1,0] neg_hi:[0,1,0]
  v_pk_fma_f32 v[64:65], v[64:65], v[42:43], v[4:5] op_sel_hi:[1,0,1] neg_lo:[0,1,0] neg_hi:[0,1,0]
  v_pk_mul_f32 v[6:7], v[42:43], v[50:51] op_sel:[1,0] op_sel_hi:[1,1] neg_lo:[0,1] neg_hi:[0,1]
  v_pk_mul_f32 v[50:51], v[50:51], v[42:43] op_sel_hi:[1,0]
  v_pk_fma_f32 v[50:51], v[42:43], v[66:67], v[50:51] op_sel:[1,0,0] op_sel_hi:[1,1,1] neg_lo:[0,1,0] neg_hi:[0,1,0]
  v_pk_fma_f32 v[66:67], v[66:67], v[42:43], v[6:7] op_sel_hi:[1,0,1] neg_lo:[0,1,0] neg_hi:[0,1,0]
  v_pk_mul_f32 v[4:5], v[42:43], v[52:53] op_sel:[1,0] op_sel_hi:[1,1] neg_lo:[0,1] neg_hi:[0,1]
  v_pk_mul_f32 v[52:53], v[52:53], v[42:43] op_sel_hi:[1,0]
  v_pk_fma_f32 v[52:53], v[42:43], v[68:69], v[52:53] op_sel:[1,0,0] op_sel_hi:[1,1,1] neg_lo:[0,1,0] neg_hi:[0,1,0]
  v_pk_fma_f32 v[68:69], v[68:69], v[42:43], v[4:5] op_sel_hi:[1,0,1] neg_lo:[0,1,0] neg_hi:[0,1,0]
  v_pk_mul_f32 v[6:7], v[42:43], v[54:55] op_sel:[1,0] op_sel_hi:[1,1] neg_lo:[0,1] neg_hi:[0,1]
  v_pk_mul_f32 v[54:55], v[54:55], v[42:43] op_sel_hi:[1,0]
  v_pk_fma_f32 v[54:55], v[42:43], v[70:71], v[54:55] op_sel:[1,0,0] op_sel_hi:[1,1,1] neg_lo:[0,1,0] neg_hi:[0,1,0]
  v_pk_fma_f32 v[70:71], v[70:71], v[42:43], v[6:7] op_sel_hi:[1,0,1] neg_lo:[0,1,0] neg_hi:[0,1,0]
  v_pk_mul_f32 v[4:5], v[42:43], v[56:57] op_sel:[1,0] op_sel_hi:[1,1] neg_lo:[0,1] neg_hi:[0,1]
  v_pk_mul_f32 v[56:57], v[56:57], v[42:43] op_sel_hi:[1,0]
  v_pk_fma_f32 v[56:57], v[42:43], v[72:73], v[56:57] op_sel:[1,0,0] op_sel_hi:[1,1,1] neg_lo:[0,1,0] neg_hi:[0,1,0]
  v_pk_fma_f32 v[72:73], v[72:73], v[42:43], v[4:5] op_sel_hi:[1,0,1] neg_lo:[0,1,0] neg_hi:[0,1,0]
  v_pk_mul_f32 v[6:7], v[42:43], v[58:59] op_sel:[1,0] op_sel_hi:[1,1] neg_lo:[0,1] neg_hi:[0,1]
  v_pk_mul_f32 v[58:59], v[58:59], v[42:43] op_sel_hi:[1,0]
  v_pk_fma_f32 v[58:59], v[42:43], v[74:75], v[58:59] op_sel:[1,0,0] op_sel_hi:[1,1,1] neg_lo:[0,1,0] neg_hi:[0,1,0]
  v_pk_fma_f32 v[74:75], v[74:75], v[42:43], v[6:7] op_sel_hi:[1,0,1] neg_lo:[0,1,0] neg_hi:[0,1,0]
  v_pk_mul_f32 v[4:5], v[42:43], v[60:61] op_sel:[1,0] op_sel_hi:[1,1] neg_lo:[0,1] neg_hi:[0,1]
  v_pk_mul_f32 v[60:61], v[60:61], v[42:43] op_sel_hi:[1,0]
  v_pk_fma_f32 v[60:61], v[42:43], v[76:77], v[60:61] op_sel:[1,0,0] op_sel_hi:[1,1,1] neg_lo:[0,1,0] neg_hi:[0,1,0]
  v_pk_fma_f32 v[76:77], v[76:77], v[42:43], v[4:5] op_sel_hi:[1,0,1] neg_lo:[0,1,0] neg_hi:[0,1,0]
  v_pk_mul_f32 v[6:7], v[42:43], v[62:63] op_sel:[1,0] op_sel_hi:[1,1] neg_lo:[0,1] neg_hi:[0,1]
  v_pk_mul_f32 v[62:63], v[62:63], v[42:43] op_sel_hi:[1,0]
  v_pk_fma_f32 v[62:63], v[42:43], v[78:79], v[62:63] op_sel:[1,0,0] op_sel_hi:[1,1,1] neg_lo:[0,1,0] neg_hi:[0,1,0]
  v_pk_fma_f32 v[78:79], v[78:79], v[42:43], v[6:7] op_sel_hi:[1,0,1] neg_lo:[0,1,0] neg_hi:[0,1,0]
  s_waitcnt vmcnt(1)
  v_max3_u32 v0, v144, v145, v146
  v_max3_u32 v4, v147, v148, v149
  v_max3_u32 v4, v150, v151, v4
  v_max3_u32 v0, v152, v153, v0
  v_max3_u32 v4, v154, v155, v4
  v_max3_u32 v0, v156, v157, v0
  v_max3_u32 v4, v158, v159, v4
  v_max_u32 v0, v0, v4
  v_cmp_eq_u32 vcc, -1, v0
  s_nop 0
  s_cmp_eq_u64 vcc, 0
  s_cbranch_scc0 L_epoll
L_eok:
  s_setprio 2
  v_fma_f32 v156, v32, v158, v156
  v_fma_f32 v157, v32, v159, v157
  v_fma_f32 v156, -v33, v159, v156
  v_fmac_f32 v157, v33, v158
  v_fma_f32 v154, v32, v156, v154
  v_fma_f32 v155, v32, v157, v155
  v_fma_f32 v154, -v33, v157, v154
  v_fmac_f32 v155, v33, v156
  v_fma_f32 v152, v32, v154, v152
  v_fma_f32 v153, v32, v155, v153
  v_fma_f32 v152, -v33, v155, v152
  v_fmac_f32 v153, v33, v154
  v_fma_f32 v150, v32, v152, v150
  v_fma_f32 v151, v32, v153, v151
  v_fma_f32 v150, -v33, v153, v150
  v_fmac_f32 v151, v33, v152
  v_fma_f32 v148, v32, v150, v148
  v_fma_f32 v149, v32, v151, v149
  v_fma_f32 v148, -v33, v151, v148
  v_fmac_f32 v149, v33, v150
  v_fma_f32 v146, v32, v148, v146
  v_fma_f32 v147, v32, v149, v147
  v_fma_f32 v146, -v33, v149, v146
  v_fmac_f32 v147, v33, v148
  v_fma_f32 v144, v32, v146, v144
  v_fma_f32 v145, v32, v147, v145
  v_fma_f32 v144, -v33, v147, v144
  v_fmac_f32 v145, v33, v146
  s_bitcmp1_b32 s77, 0
  s_cselect_b32 vcc_lo, 0xffff, 0
  s_mov_b32 vcc_hi, 0
  v_cndmask_b32 v144, v144, v146, vcc
  v_cndmask_b32 v145, v145, v147, vcc
  v_mul_f32 v4, v36, v144
  v_mul_f32 v5, v36, v145
  v_fma_f32 v4, -v37, v145, v4
  v_fmac_f32 v5, v37, v144
  v_mov_b32 v6, v4
  v_mov_b32 v7, v5
  s_nop 0
  v_permlane16_swap_b32 v6, v4
  v_permlane16_swap_b32 v7, v5
  v_add_f32 v4, v6, v4
  v_add_f32 v5, v7, v5
  v_mov_b32 v6, v4
  v_mov_b32 v7, v5
  s_nop 0
  v_permlane32_swap_b32 v6, v4
  v_permlane32_swap_b32 v7, v5
  v_add_f32 v4, v6, v4
  v_add_f32 v5, v7, v5
  v_fma_f32 v44, v34, v4, v44
  v_fma_f32 v45, v34, v5, v45
  v_fma_f32 v44, -v35, v5, v44
  v_fmac_f32 v45, v35, v4
  v_pk_fma_f32 v[48:49], v[80:81], v[44:45], v[48:49] op_sel_hi:[1,0,1]
  v_pk_fma_f32 v[48:49], v[44:45], v[96:97], v[48:49] op_sel:[1,0,0] op_sel_hi:[1,1,1] neg_lo:[0,1,0] neg_hi:[0,1,0]
  v_pk_fma_f32 v[50:51], v[82:83], v[44:45], v[50:51] op_sel_hi:[1,0,1]
  v_pk_fma_f32 v[50:51], v[44:45], v[98:99], v[50:51] op_sel:[1,0,0] op_sel_hi:[1,1,1] neg_lo:[0,1,0] neg_hi:[0,1,0]
  v_pk_fma_f32 v[52:53], v[84:85], v[44:45], v[52:53] op_sel_hi:[1,0,1]
  v_pk_fma_f32 v[52:53], v[44:45], v[100:101], v[52:53] op_sel:[1,0,0] op_sel_hi:[1,1,1] neg_lo:[0,1,0] neg_hi:[0,1,0]
  v_pk_fma_f32 v[54:55], v[86:87], v[44:45], v[54:55] op_sel_hi:[1,0,1]
  v_pk_fma_f32 v[54:55], v[44:45], v[102:103], v[54:55] op_sel:[1,0,0] op_sel_hi:[1,1,1] neg_lo:[0,1,0] neg_hi:[0,1,0]
  v_pk_fma_f32 v[56:57], v[88:89], v[44:45], v[56:57] op_sel_hi:[1,0,1]
  v_pk_fma_f32 v[56:57], v[44:45], v[104:105], v[56:57] op_sel:[1,0,0] op_sel_hi:[1,1,1] neg_lo:[0,1,0] neg_hi:[0,1,0]
  v_pk_fma_f32 v[58:59], v[90:91], v[44:45], v[58:59] op_sel_hi:[1,0,1]
  v_pk_fma_f32 v[58:59], v[44:45], v[106:107], v[58:59] op_sel:[1,0,0] op_sel_hi:[1,1,1] neg_lo:[0,1,0] neg_hi:[0,1,0]
  v_pk_fma_f32 v[60:61], v[92:93], v[44:45], v[60:61] op_sel_hi:[1,0,1]
  v_pk_fma_f32 v[60:61], v[44:45], v[108:109], v[60:61] op_sel:[1,0,0] op_sel_hi:[1,1,1] neg_lo:[0,1,0] neg_hi:[0,1,0]
  v_pk_fma_f32 v[62:63], v[94:95], v[44:45], v[62:63] op_sel_hi:[1,0,1]
  v_pk_fma_f32 v[62:63], v[44:45], v[110:111], v[62:63] op_sel:[1,0,0] op_sel_hi:[1,1,1] neg_lo:[0,1,0] neg_hi:[0,1,0]
  v_pk_fma_f32 v[64:65], v[44:45], v[80:81], v[64:65] op_sel:[1,0,0] op_sel_hi:[1,1,1] neg_lo:[0,1,0] neg_hi:[0,1,0]
  v_pk_fma_f32 v[64:65], v[96:97], v[44:45], v[64:65] op_sel_hi:[1,0,1] neg_lo:[0,1,0] neg_hi:[0,1,0]
  v_pk_fma_f32 v[66:67], v[44:45], v[82:83], v[66:67] op_sel:[1,0,0] op_sel_hi:[1,1,1] neg_lo:[0,1,0] neg_hi:[0,1,0]
  v_pk_fma_f32 v[66:67], v[98:99], v[44:45], v[66:67] op_sel_hi:[1,0,1] neg_lo:[0,1,0] neg_hi:[0,1,0]
  v_pk_fma_f32 v[68:69], v[44:45], v[84:85], v[68:69] op_sel:[1,0,0] op_sel_hi:[1,1,1] neg_lo:[0,1,0] neg_hi:[0,1,0]
  v_pk_fma_f32 v[68:69], v[100:101], v[44:45], v[68:69] op_sel_hi:[1,0,1] neg_lo:[0,1,0] neg_hi:[0,1,0]
  v_pk_fma_f32 v[70:71], v[44:45], v[86:87], v[70:71] op_sel:[1,0,0] op_sel_hi:[1,1,1] neg_lo:[0,1,0] neg_hi:[0,1,0]
  v_pk_fma_f32 v[70:71], v[102:103], v[44:45], v[70:71] op_sel_hi:[1,0,1] neg_lo:[0,1,0] neg_hi:[0,1,0]
  v_pk_fma_f32 v[72:73], v[44:45], v[88:89], v[72:73] op_sel:[1,0,0] op_sel_hi:[1,1,1] neg_lo:[0,1,0] neg_hi:[0,1,0]
  v_pk_fma_f32 v[72:73], v[104:105], v[44:45], v[72:73] op_sel_hi:[1,0,1] neg_lo:[0,1,0] neg_hi:[0,1,0]
  v_pk_fma_f32 v[74:75], v[44:45], v[90:91], v[74:75] op_sel:[1,0,0] op_sel_hi:[1,1,1] neg_lo:[0,1,0] neg_hi:[0,1,0]
  v_pk_fma_f32 v[74:75], v[106:107], v[44:45], v[74:75] op_sel_hi:[1,0,1] neg_lo:[0,1,0] neg_hi:[0,1,0]
  v_pk_fma_f32 v[76:77], v[44:45], v[92:93], v[76:77] op_sel:[1,0,0] op_sel_hi:[1,1,1] neg_lo:[0,1,0] neg_hi:[0,1,0]
  v_pk_fma_f32 v[76:77], v[108:109], v[44:45], v[76:77] op_sel_hi:[1,0,1] neg_lo:[0,1,0] neg_hi:[0,1,0]
  v_pk_fma_f32 v[78:79], v[44:45], v[94:95], v[78:79] op_sel:[1,0,0] op_sel_hi:[1,1,1] neg_lo:[0,1,0] neg_hi:[0,1,0]
  v_pk_fma_f32 v[78:79], v[110:111], v[44:45], v[78:79] op_sel_hi:[1,0,1] neg_lo:[0,1,0] neg_hi:[0,1,0]
  v_cvt_pk_bf16_f32 v48, v48, v49
  v_cvt_pk_bf16_f32 v49, v50, v51
  v_cvt_pk_bf16_f32 v50, v52, v53
  v_cvt_pk_bf16_f32 v51, v54, v55
  v_cvt_pk_bf16_f32 v52, v56, v57
  v_cvt_pk_bf16_f32 v53, v58, v59
  v_cvt_pk_bf16_f32 v54, v60, v61
  v_cvt_pk_bf16_f32 v55, v62, v63
  v_mfma_f32_16x16x32_bf16 v[112:115], v[48:51], v[18:21], 0
  v_mfma_f32_16x16x32_bf16 v[116:119], v[48:51], v[16:19], 0
  v_mfma_f32_16x16x32_bf16 v[120:123], v[52:55], v[18:21], 0
  v_mfma_f32_16x16x32_bf16 v[124:127], v[52:55], v[16:19], 0
  v_cvt_pk_bf16_f32 v64, v64, v65
  v_cvt_pk_bf16_f32 v65, v66, v67
  v_cvt_pk_bf16_f32 v66, v68, v69
  v_cvt_pk_bf16_f32 v67, v70, v71
  v_cvt_pk_bf16_f32 v68, v72, v73
  v_cvt_pk_bf16_f32 v69, v74, v75
  v_cvt_pk_bf16_f32 v70, v76, v77
  v_cvt_pk_bf16_f32 v71, v78, v79
  v_mfma_f32_16x16x32_bf16 v[128:131], v[64:67], v[18:21], 0
  v_mfma_f32_16x16x32_bf16 v[132:135], v[64:67], v[16:19], 0
  v_mfma_f32_16x16x32_bf16 v[136:139], v[68:71], v[18:21], 0
  v_mfma_f32_16x16x32_bf16 v[140:143], v[68:71], v[16:19], 0
  v_cvt_pk_bf16_f32 v56, v112, v113
  v_cvt_pk_bf16_f32 v57, v114, v115
  v_cvt_pk_bf16_f32 v58, v116, v117
  v_cvt_pk_bf16_f32 v59, v118, v119
  v_cvt_pk_bf16_f32 v60, v120, v121
  v_cvt_pk_bf16_f32 v61, v122, v123
  v_cvt_pk_bf16_f32 v62, v124, v125
  v_cvt_pk_bf16_f32 v63, v126, v127
  s_waitcnt vmcnt(0)
  s_mov_b64 exec, 1
  buffer_atomic_add v2, v3, s[12:15], s84 offen sc1
  s_mov_b64 exec, -1
  v_permlane16_swap_b32 v56, v58
  v_permlane16_swap_b32 v57, v59
  s_add_u32 s91, s88, 0
  buffer_store_dwordx4 v[56:59], v15, s[12:15], s91 offen sc1
  v_permlane16_swap_b32 v60, v62
  v_permlane16_swap_b32 v61, v63
  s_add_u32 s91, s88, 153600
  buffer_store_dwordx4 v[60:63], v15, s[12:15], s91 offen sc1
  v_cvt_pk_bf16_f32 v72, v128, v129
  v_cvt_pk_bf16_f32 v73, v130, v131
  v_cvt_pk_bf16_f32 v74, v132, v133
  v_cvt_pk_bf16_f32 v75, v134, v135
  v_cvt_pk_bf16_f32 v76, v136, v137
  v_cvt_pk_bf16_f32 v77, v138, v139
  v_cvt_pk_bf16_f32 v78, v140, v141
  v_cvt_pk_bf16_f32 v79, v142, v143
  v_permlane16_swap_b32 v72, v74
  v_permlane16_swap_b32 v73, v75
  s_add_u32 s91, s88, 32768
  buffer_store_dwordx4 v[72:75], v15, s[12:15], s91 offen sc1
  v_permlane16_swap_b32 v76, v78
  v_permlane16_swap_b32 v77, v79
  s_add_u32 s91, s88, 186368
  buffer_store_dwordx4 v[76:79], v15, s[12:15], s91 offen sc1
  s_add_u32 m0, s99, 0
  s_add_u32 s90, s75, 327680
  buffer_load_dwordx4 v14, s[28:31], s90 offen lds
  s_add_u32 s90, s75, 334848
  buffer_load_dwordx4 v14, s[28:31], s90 offen offset:1024 lds
  v_and_b32 v12, 31, v1
  v_lshrrev_b32 v13, 5, v1
  v_bfe_u32 v0, v1, 1, 3
  v_xor_b32 v0, v13, v0
  v_lshlrev_b32 v0, 4, v0
  v_lshl_add_u32 v0, v12, 7, v0
  v_add_u32 v4, s95, v0
  v_add_u32 v8, s96, v0
  v_xor_b32 v5, 32, v4
  v_xor_b32 v9, 32, v8
  v_xor_b32 v6, 64, v4
  v_xor_b32 v10, 64, v8
  v_xor_b32 v7, 96, v4
  v_xor_b32 v11, 96, v8
  v_bfe_u32 v0, v1, 2, 2
  v_lshrrev_b32 v12, 5, v1
  v_lshl_add_u32 v0, v12, 3, v0
  v_lshlrev_b32 v0, 7, v0
  v_and_b32 v12, 3, v1
  v_lshl_add_u32 v0, v12, 3, v0
  v_bfe_u32 v12, v1, 4, 1
  v_lshl_add_u32 v0, v12, 5, v0
  v_bfe_u32 v12, v1, 3, 1
  v_lshl_add_u32 v0, v12, 6, v0
  v_xor_b32 v12, 64, v0
  v_add_u32 v148, s96, v0
  v_add_u32 v149, s96, v12
  v_add_u32 v144, s99, v0
  v_add_u32 v145, s99, v12
  s_lshl_b32 s91, s77, 2
  s_add_u32 s91, s91, 163584
  v_mov_b32 v13, s91
  s_lshl_b32 s90, s85, 2
  s_add_u32 s90, s90, s86
  s_mul_i32 s88, s90, 307200
  s_lshl_b32 s94, s90, 2
  s_add_u32 s94, s94, s77
  s_lshl_b32 s94, s94, 8
  s_add_u32 s94, s94, 10616960
  s_lshl_b32 s90, s93, 10
  s_add_u32 s89, s88, s90
  s_lshl_b32 s90, s77, 13
  s_add_u32 s88, s88, s90
  s_and_b32 s92, s86, 3
  s_xor_b32 s90, s92, 0
  s_and_b32 s91, s90, 1
  s_lshl_b32 s91, s91, 15
  s_and_b32 s90, s90, 2
  s_lshl_b32 s90, s90, 11
  s_add_u32 s90, s90, s91
  s_add_u32 s60, s88, s90
  s_xor_b32 s90, s92, 1
  s_and_b32 s91, s90, 1
  s_lshl_b32 s91, s91, 15
  s_and_b32 s90, s90, 2
  s_lshl_b32 s90, s90, 11
  s_add_u32 s90, s90, s91
  s_add_u32 s61, s88, s90
  s_xor_b32 s90, s92, 2
  s_and_b32 s91, s90, 1
  s_lshl_b32 s91, s91, 15
  s_and_b32 s90, s90, 2
  s_lshl_b32 s90, s90, 11
  s_add_u32 s90, s90, s91
  s_add_u32 s64, s88, s90
  s_xor_b32 s90, s92, 3
  s_and_b32 s91, s90, 1
  s_lshl_b32 s91, s91, 15
  s_and_b32 s90, s90, 2
  s_lshl_b32 s90, s90, 11
  s_add_u32 s90, s90, s91
  s_add_u32 s65, s88, s90
  s_waitcnt vmcnt(2)
  s_mov_b64 exec, 1
  buffer_atomic_add v2, v3, s[12:15], s98 offen sc1
  s_mov_b64 exec, -1
  s_cmp_ge_u32 s77, 2
  s_cbranch_scc1 L_no14
  s_add_u32 m0, s99, 2048
  s_add_u32 s90, s75, 344064
  buffer_load_dwordx4 v14, s[28:31], s90 offen lds
  s_add_u32 s90, s75, 351232
  buffer_load_dwordx4 v14, s[28:31], s90 offen offset:1024 lds
L_no14:
  s_setprio 0
  s_cmp_ge_u32 s77, 2
  s_cselect_b32 s83, 0x40000000, s89
  s_cselect_b32 s91, 0, 2048
  v_add_u32 v146, s91, v144
  v_add_u32 v147, s91, v145
  s_mov_b32 s97, 0
L_z0:
  s_sleep 1
  ds_read_b32 v0, v13
  s_add_u32 s97, s97, 1
  s_waitcnt lgkmcnt(0)
  v_cmp_ne_u32 vcc, 1, v0
  s_cmp_gt_u32 s97, 1000000
  s_cselect_b64 vcc, 0, vcc
  s_cmp_eq_u64 vcc, 0
  s_cbranch_scc0 L_z0
  ds_read_b128 v[112:115], v4 offset:16384
  ds_read_b128 v[116:119], v4 offset:20480
  ds_read_b128 v[120:123], v5 offset:16384
  ds_read_b128 v[124:127], v5 offset:20480
  ds_read_b128 v[128:131], v6 offset:16384
  ds_read_b128 v[132:135], v6 offset:20480
  ds_read_b128 v[136:139], v7 offset:16384
  ds_read_b128 v[140:143], v7 offset:20480
  ds_read_b128 v[160:163], v4 offset:0
  ds_read_b128 v[164:167], v4 offset:4096
  ds_read_b128 v[168:171], v5 offset:0
  ds_read_b128 v[172:175], v5 offset:4096
  ds_read_b128 v[176:179], v6 offset:0
  ds_read_b128 v[180:183], v6 offset:4096
  ds_read_b128 v[184:187], v7 offset:0
  ds_read_b128 v[188:191], v7 offset:4096
  ds_read_b128 v[192:195], v4 offset:8192
  ds_read_b128 v[196:199], v4 offset:12288
  ds_read_b128 v[200:203], v5 offset:8192
  ds_read_b128 v[204:207], v5 offset:12288
  ds_read_b128 v[208:211], v6 offset:8192
  ds_read_b128 v[212:215], v6 offset:12288
  ds_read_b128 v[216:219], v7 offset:8192
  ds_read_b128 v[220:223], v7 offset:12288
  ds_read_b128 v[224:227], v8 offset:0
  ds_read_b128 v[228:231], v8 offset:16640
  ds_read_b128 v[232:235], v9 offset:0
  ds_read_b128 v[236:239], v9 offset:16640
  ds_read_b128 v[240:243], v10 offset:0
  ds_read_b128 v[244:247], v10 offset:16640
  ds_read_b128 v[248:251], v11 offset:0
  ds_read_b128 v[252:255], v11 offset:16640
  s_waitcnt lgkmcnt(0)
  s_lshl_b32 s91, s77, 11
  s_add_u32 s91, s91, 16384
  v_add_u32 v4, s91, v15
  s_lshl_b32 s91, s77, 11
  s_add_u32 s91, s91, 40960
  v_add_u32 v5, s91, v15
  s_lshl_b32 s91, s77, 11
  s_add_u32 s91, s91, 65536
  v_add_u32 v6, s91, v15
  s_lshl_b32 s91, s77, 11
  s_add_u32 s91, s91, 90112
  v_add_u32 v7, s91, v15
  s_lshl_b32 s91, s77, 10
  s_add_u32 s91, s91, 98304
  v_add_u32 v8, s91, v15
  s_barrier
  s_load_dword s55, s[66:67], s94 glc
  s_waitcnt lgkmcnt(0)
  s_cmp_lt_u32 s55, 8
  s_cbranch_scc1 L_fp0
L_fp0_ok:
  s_add_u32 s90, s60, 88064
  buffer_load_dwordx4 v[16:19], v15, s[12:15], s90 offen sc1
  s_add_u32 s90, s60, 241664
  buffer_load_dwordx4 v[20:23], v15, s[12:15], s90 offen sc1
  s_add_u32 s90, s60, 89088
  buffer_load_dwordx4 v[24:27], v15, s[12:15], s90 offen sc1
  s_add_u32 s90, s60, 242688
  buffer_load_dwordx4 v[28:31], v15, s[12:15], s90 offen sc1
  s_add_u32 s90, s60, 90112
  buffer_load_dwordx4 v[32:35], v15, s[12:15], s90 offen sc1
  s_add_u32 s90, s60, 243712
  buffer_load_dwordx4 v[36:39], v15, s[12:15], s90 offen sc1
  s_add_u32 s90, s60, 91136
  buffer_load_dwordx4 v[40:43], v15, s[12:15], s90 offen sc1
  s_add_u32 s90, s60, 244736
  buffer_load_dwordx4 v[44:47], v15, s[12:15], s90 offen sc1
  s_add_u32 s90, s89, 18432
  buffer_load_dwordx4 v[152:155], v15, s[12:15], s90 offen sc1
  s_add_u32 s90, s89, 172032
  buffer_load_dwordx4 v[156:159], v15, s[12:15], s90 offen sc1
  s_waitcnt vmcnt(9)
  v_mfma_f32_32x32x16_bf16 v[48:63], v[16:19], v[112:115], 0
  v_mfma_f32_32x32x16_bf16 v[64:79], v[16:19], v[116:119], 0
  s_add_u32 s90, s89, 19456
  buffer_load_dwordx4 v[16:19], v15, s[12:15], s90 offen sc1
  s_waitcnt vmcnt(9)
  v_mfma_f32_32x32x16_bf16 v[80:95], v[20:23], v[112:115], 0
  v_mfma_f32_32x32x16_bf16 v[96:111], v[20:23], v[116:119], 0
  s_add_u32 s90, s89, 173056
  buffer_load_dwordx4 v[20:23], v15, s[12:15], s90 offen sc1
  s_waitcnt vmcnt(9)
  v_mfma_f32_32x32x16_bf16 v[48:63], v[24:27], v[120:123], v[48:63]
  ds_read_b64_tr_b16 v[112:113], v148 offset:33280
  ds_read_b64_tr_b16 v[114:115], v148 offset:33792
  v_mfma_f32_32x32x16_bf16 v[64:79], v[24:27], v[124:127], v[64:79]
  s_add_u32 s90, s89, 20480
  buffer_load_dwordx4 v[24:27], v15, s[12:15], s90 offen sc1
  ds_read_b64_tr_b16 v[116:117], v149 offset:33280
  ds_read_b64_tr_b16 v[118:119], v149 offset:33792
  s_waitcnt vmcnt(9)
  v_mfma_f32_32x32x16_bf16 v[80:95], v[28:31], v[120:123], v[80:95]
  v_mfma_f32_32x32x16_bf16 v[96:111], v[28:31], v[124:127], v[96:111]
  s_add_u32 s90, s89, 174080
  buffer_load_dwordx4 v[28:31], v15, s[12:15], s90 offen sc1
  s_waitcnt vmcnt(9)
  v_mfma_f32_32x32x16_bf16 v[48:63], v[32:35], v[128:131], v[48:63]
  ds_read_b64_tr_b16 v[120:121], v148 offset:35328
  ds_read_b64_tr_b16 v[122:123], v148 offset:35840
  v_mfma_f32_32x32x16_bf16 v[64:79], v[32:35], v[132:135], v[64:79]
  s_add_u32 s90, s83, 21504
  buffer_load_dwordx4 v[32:35], v15, s[12:15], s90 offen sc1
  ds_read_b64_tr_b16 v[124:125], v149 offset:35328
  ds_read_b64_tr_b16 v[126:127], v149 offset:35840
  s_waitcnt vmcnt(9)
  v_mfma_f32_32x32x16_bf16 v[80:95], v[36:39], v[128:131], v[80:95]
  v_mfma_f32_32x32x16_bf16 v[96:111], v[36:39], v[132:135], v[96:111]
  s_add_u32 s90, s83, 175104
  buffer_load_dwordx4 v[36:39], v15, s[12:15], s90 offen sc1
  s_waitcnt vmcnt(9)
  v_mfma_f32_32x32x16_bf16 v[48:63], v[40:43], v[136:139], v[48:63]
  ds_read_b64_tr_b16 v[128:129], v144 offset:0
  ds_read_b64_tr_b16 v[130:131], v144 offset:512
  v_mfma_f32_32x32x16_bf16 v[64:79], v[40:43], v[140:143], v[64:79]
  s_add_u32 s90, s61, 88064
  buffer_load_dwordx4 v[40:43], v15, s[12:15], s90 offen sc1
  ds_read_b64_tr_b16 v[132:133], v145 offset:0
  ds_read_b64_tr_b16 v[134:135], v145 offset:512
  s_waitcnt vmcnt(9)
  v_mfma_f32_32x32x16_bf16 v[80:95], v[44:47], v[136:139], v[80:95]
  v_mfma_f32_32x32x16_bf16 v[96:111], v[44:47], v[140:143], v[96:111]
  s_add_u32 s90, s61, 89088
  buffer_load_dwordx4 v[44:47], v15, s[12:15], s90 offen sc1
  s_waitcnt lgkmcnt(8)
  s_waitcnt vmcnt(9)
  v_mfma_f32_32x32x16_bf16 v[48:63], v[152:155], v[112:115], v[48:63]
  ds_read_b64_tr_b16 v[136:137], v146 offset:0
  ds_read_b64_tr_b16 v[138:139], v146 offset:512
  v_mfma_f32_32x32x16_bf16 v[64:79], v[152:155], v[116:119], v[64:79]
  s_add_u32 s90, s61, 90112
  buffer_load_dwordx4 v[152:155], v15, s[12:15], s90 offen sc1
  ds_read_b64_tr_b16 v[140:141], v147 offset:0
  ds_read_b64_tr_b16 v[142:143], v147 offset:512
  s_waitcnt vmcnt(9)
  v_mfma_f32_32x32x16_bf16 v[80:95], v[156:159], v[112:115], v[80:95]
  v_mfma_f32_32x32x16_bf16 v[96:111], v[156:159], v[116:119], v[96:111]
  s_add_u32 s90, s61, 91136
  buffer_load_dwordx4 v[156:159], v15, s[12:15], s90 offen sc1
  s_waitcnt lgkmcnt(8)
  s_waitcnt vmcnt(9)
  v_mfma_f32_32x32x16_bf16 v[48:63], v[16:19], v[120:123], v[48:63]
  v_mfma_f32_32x32x16_bf16 v[64:79], v[16:19], v[124:127], v[64:79]
  s_add_u32 s90, s64, 88064
  buffer_load_dwordx4 v[16:19], v15, s[12:15], s90 offen sc1
  s_waitcnt vmcnt(9)
  v_mfma_f32_32x32x16_bf16 v[80:95], v[20:23], v[120:123], v[80:95]
  v_mfma_f32_32x32x16_bf16 v[96:111], v[20:23], v[124:127], v[96:111]
  s_add_u32 s90, s64, 89088
  buffer_load_dwordx4 v[20:23], v15, s[12:15], s90 offen sc1
  s_waitcnt lgkmcnt(4)
  s_waitcnt vmcnt(9)
  v_mfma_f32_32x32x16_bf16 v[48:63], v[24:27], v[128:131], v[48:63]
  v_mfma_f32_32x32x16_bf16 v[64:79], v[24:27], v[132:135], v[64:79]
  s_add_u32 s90, s64, 90112
  buffer_load_dwordx4 v[24:27], v15, s[12:15], s90 offen sc1
  s_waitcnt vmcnt(9)
  v_mfma_f32_32x32x16_bf16 v[80:95], v[28:31], v[128:131], v[80:95]
  v_mfma_f32_32x32x16_bf16 v[96:111], v[28:31], v[132:135], v[96:111]
  s_add_u32 s90, s64, 91136
  buffer_load_dwordx4 v[28:31], v15, s[12:15], s90 offen sc1
  s_waitcnt lgkmcnt(0)
  s_waitcnt vmcnt(9)
  v_mfma_f32_32x32x16_bf16 v[48:63], v[32:35], v[136:139], v[48:63]
  v_mfma_f32_32x32x16_bf16 v[64:79], v[32:35], v[140:143], v[64:79]
  s_add_u32 s90, s65, 88064
  buffer_load_dwordx4 v[32:35], v15, s[12:15], s90 offen sc1
  s_waitcnt vmcnt(9)
  v_mfma_f32_32x32x16_bf16 v[80:95], v[36:39], v[136:139], v[80:95]
  v_mfma_f32_32x32x16_bf16 v[96:111], v[36:39], v[140:143], v[96:111]
  s_add_u32 s90, s65, 89088
  buffer_load_dwordx4 v[36:39], v15, s[12:15], s90 offen sc1
  s_waitcnt vmcnt(9)
  v_mfma_f32_32x32x16_bf16 v[48:63], v[40:43], v[160:163], v[48:63]
  v_mfma_f32_32x32x16_bf16 v[64:79], v[40:43], v[164:167], v[64:79]
  s_add_u32 s90, s65, 90112
  buffer_load_dwordx4 v[40:43], v15, s[12:15], s90 offen sc1
  s_waitcnt vmcnt(9)
  v_mfma_f32_32x32x16_bf16 v[48:63], v[44:47], v[168:171], v[48:63]
  v_mfma_f32_32x32x16_bf16 v[64:79], v[44:47], v[172:175], v[64:79]
  s_add_u32 s90, s65, 91136
  buffer_load_dwordx4 v[44:47], v15, s[12:15], s90 offen sc1
  s_waitcnt vmcnt(9)
  v_mfma_f32_32x32x16_bf16 v[48:63], v[152:155], v[176:179], v[48:63]
  v_mfma_f32_32x32x16_bf16 v[64:79], v[152:155], v[180:183], v[64:79]
  s_add_u32 s90, s61, 241664
  buffer_load_dwordx4 v[152:155], v15, s[12:15], s90 offen sc1
  s_waitcnt vmcnt(9)
  v_mfma_f32_32x32x16_bf16 v[48:63], v[156:159], v[184:187], v[48:63]
  v_mfma_f32_32x32x16_bf16 v[64:79], v[156:159], v[188:191], v[64:79]
  s_add_u32 s90, s61, 242688
  buffer_load_dwordx4 v[156:159], v15, s[12:15], s90 offen sc1
  s_barrier
  s_waitcnt vmcnt(9)
  v_mfma_f32_32x32x16_bf16 v[48:63], v[16:19], v[192:195], v[48:63]
  v_mfma_f32_32x32x16_bf16 v[64:79], v[16:19], v[196:199], v[64:79]
  s_add_u32 s90, s61, 243712
  buffer_load_dwordx4 v[16:19], v15, s[12:15], s90 offen sc1
  s_waitcnt vmcnt(9)
  v_mfma_f32_32x32x16_bf16 v[48:63], v[20:23], v[200:203], v[48:63]
  v_mfma_f32_32x32x16_bf16 v[64:79], v[20:23], v[204:207], v[64:79]
  s_add_u32 s90, s61, 244736
  buffer_load_dwordx4 v[20:23], v15, s[12:15], s90 offen sc1
  s_waitcnt vmcnt(9)
  v_mfma_f32_32x32x16_bf16 v[48:63], v[24:27], v[208:211], v[48:63]
  v_mfma_f32_32x32x16_bf16 v[64:79], v[24:27], v[212:215], v[64:79]
  s_add_u32 s90, s64, 241664
  buffer_load_dwordx4 v[24:27], v15, s[12:15], s90 offen sc1
  s_waitcnt vmcnt(9)
  v_mfma_f32_32x32x16_bf16 v[48:63], v[28:31], v[216:219], v[48:63]
  v_mfma_f32_32x32x16_bf16 v[64:79], v[28:31], v[220:223], v[64:79]
  s_add_u32 s90, s64, 242688
  buffer_load_dwordx4 v[28:31], v15, s[12:15], s90 offen sc1
  s_waitcnt vmcnt(9)
  v_mfma_f32_32x32x16_bf16 v[48:63], v[32:35], v[224:227], v[48:63]
  v_mfma_f32_32x32x16_bf16 v[64:79], v[32:35], v[228:231], v[64:79]
  s_add_u32 s90, s64, 243712
  buffer_load_dwordx4 v[32:35], v15, s[12:15], s90 offen sc1
  s_waitcnt vmcnt(9)
  v_mfma_f32_32x32x16_bf16 v[48:63], v[36:39], v[232:235], v[48:63]
  v_mfma_f32_32x32x16_bf16 v[64:79], v[36:39], v[236:239], v[64:79]
  s_add_u32 s90, s64, 244736
  buffer_load_dwordx4 v[36:39], v15, s[12:15], s90 offen sc1
  s_waitcnt vmcnt(9)
  v_mfma_f32_32x32x16_bf16 v[48:63], v[40:43], v[240:243], v[48:63]
  v_mfma_f32_32x32x16_bf16 v[64:79], v[40:43], v[244:247], v[64:79]
  s_add_u32 s90, s65, 241664
  buffer_load_dwordx4 v[40:43], v15, s[12:15], s90 offen sc1
  s_waitcnt vmcnt(9)
  v_mfma_f32_32x32x16_bf16 v[48:63], v[44:47], v[248:251], v[48:63]
  v_mfma_f32_32x32x16_bf16 v[64:79], v[44:47], v[252:255], v[64:79]
  s_add_u32 s90, s65, 242688
  buffer_load_dwordx4 v[44:47], v15, s[12:15], s90 offen sc1
  s_waitcnt vmcnt(9)
  v_mfma_f32_32x32x16_bf16 v[80:95], v[152:155], v[160:163], v[80:95]
  v_mfma_f32_32x32x16_bf16 v[96:111], v[152:155], v[164:167], v[96:111]
  s_add_u32 s90, s65, 243712
  buffer_load_dwordx4 v[152:155], v15, s[12:15], s90 offen sc1
  s_waitcnt vmcnt(9)
  v_mfma_f32_32x32x16_bf16 v[80:95], v[156:159], v[168:171], v[80:95]
  v_mfma_f32_32x32x16_bf16 v[96:111], v[156:159], v[172:175], v[96:111]
  s_add_u32 s90, s65, 244736
  buffer_load_dwordx4 v[156:159], v15, s[12:15], s90 offen sc1
  ds_write_b128 v4, v[48:51] offset:0
  s_waitcnt vmcnt(9)
  v_mfma_f32_32x32x16_bf16 v[80:95], v[16:19], v[176:179], v[80:95]
  ds_write_b128 v5, v[52:55] offset:0
  v_mfma_f32_32x32x16_bf16 v[96:111], v[16:19], v[180:183], v[96:111]
  ds_write_b128 v6, v[56:59] offset:0
  s_waitcnt vmcnt(8)
  v_mfma_f32_32x32x16_bf16 v[80:95], v[20:23], v[184:187], v[80:95]
  ds_write_b128 v7, v[60:63] offset:0
  v_mfma_f32_32x32x16_bf16 v[96:111], v[20:23], v[188:191], v[96:111]
  ds_write_b128 v4, v[64:67] offset:1024
  s_waitcnt vmcnt(7)
  v_mfma_f32_32x32x16_bf16 v[80:95], v[24:27], v[192:195], v[80:95]
  ds_write_b128 v5, v[68:71] offset:1024
  v_mfma_f32_32x32x16_bf16 v[96:111], v[24:27], v[196:199], v[96:111]
  ds_write_b128 v6, v[72:75] offset:1024
  s_waitcnt vmcnt(6)
  v_mfma_f32_32x32x16_bf16 v[80:95], v[28:31], v[200:203], v[80:95]
  ds_write_b128 v7, v[76:79] offset:1024
  v_mfma_f32_32x32x16_bf16 v[96:111], v[28:31], v[204:207], v[96:111]
  s_waitcnt lgkmcnt(0)
  s_barrier
  s_waitcnt vmcnt(5)
  v_mfma_f32_32x32x16_bf16 v[80:95], v[32:35], v[208:211], v[80:95]
  s_waitcnt vmcnt(4)
  v_mfma_f32_32x32x16_bf16 v[80:95], v[36:39], v[216:219], v[80:95]
  s_waitcnt vmcnt(3)
  v_mfma_f32_32x32x16_bf16 v[80:95], v[40:43], v[224:227], v[80:95]
  s_waitcnt vmcnt(2)
  v_mfma_f32_32x32x16_bf16 v[80:95], v[44:47], v[232:235], v[80:95]
  s_waitcnt vmcnt(1)
  v_mfma_f32_32x32x16_bf16 v[80:95], v[152:155], v[240:243], v[80:95]
  s_waitcnt vmcnt(0)
  v_mfma_f32_32x32x16_bf16 v[80:95], v[156:159], v[248:251], v[80:95]
  v_mfma_f32_32x32x16_bf16 v[96:111], v[32:35], v[212:215], v[96:111]
  s_nop 4
  v_mfma_f32_32x32x16_bf16 v[96:111], v[36:39], v[220:223], v[96:111]
  s_nop 3
  v_mfma_f32_32x32x16_bf16 v[96:111], v[40:43], v[228:231], v[96:111]
  ds_write_b128 v8, v[80:83] offset:0
  v_mfma_f32_32x32x16_bf16 v[96:111], v[44:47], v[236:239], v[96:111]
  ds_write_b128 v8, v[84:87] offset:4096
  v_mfma_f32_32x32x16_bf16 v[96:111], v[152:155], v[244:247], v[96:111]
  ds_write_b128 v8, v[88:91] offset:8192
  v_mfma_f32_32x32x16_bf16 v[96:111], v[156:159], v[252:255], v[96:111]
  ds_write_b128 v8, v[92:95] offset:12288
  s_waitcnt lgkmcnt(0)
  s_barrier
  s_nop 8
  ds_write_b128 v8, v[96:99] offset:16640
  ds_write_b128 v8, v[100:103] offset:20736
  ds_write_b128 v8, v[104:107] offset:24832
  ds_write_b128 v8, v[108:111] offset:28928
  s_waitcnt lgkmcnt(0)
  s_barrier
L_end:
  s_endpgm
L_epoll:
  s_waitcnt vmcnt(0)
  s_mov_b64 exec, 1
  buffer_atomic_add v2, v3, s[12:15], s84 offen sc1
  s_mov_b64 exec, -1
  s_mov_b32 s84, 0x40000000
  s_mov_b32 s97, 0
L_epoll1:
  s_sleep 4
  buffer_load_dwordx4 v[144:147], v46, s[32:35], s89 offen offset:0 sc1
  buffer_load_dwordx4 v[148:151], v46, s[32:35], s89 offen offset:256 sc1
  buffer_load_dwordx4 v[152:155], v46, s[32:35], s89 offen offset:512 sc1
  buffer_load_dwordx4 v[156:159], v46, s[32:35], s89 offen offset:768 sc1
  s_add_u32 s97, s97, 1
  s_cmp_gt_u32 s97, 100000
  s_cbranch_scc1 L_eok
  s_waitcnt vmcnt(0)
  v_max3_u32 v0, v144, v145, v146
  v_max3_u32 v4, v147, v148, v149
  v_max3_u32 v4, v150, v151, v4
  v_max3_u32 v0, v152, v153, v0
  v_max3_u32 v4, v154, v155, v4
  v_max3_u32 v0, v156, v157, v0
  v_max3_u32 v4, v158, v159, v4
  v_max_u32 v0, v0, v4
  v_cmp_eq_u32 vcc, -1, v0
  s_nop 0
  s_cmp_eq_u64 vcc, 0
  s_cbranch_scc0 L_epoll1
  s_branch L_eok
L_fp0:
  s_mov_b32 s97, 0
L_fp0_1:
  s_load_dword s55, s[66:67], s94 glc
  s_add_u32 s97, s97, 1
  s_waitcnt lgkmcnt(0)
  s_cmp_gt_u32 s97, 100000
  s_cselect_b32 s55, 8, s55
  s_cmp_lt_u32 s55, 8
  s_cbranch_scc0 L_fp0_ok
  s_sleep 4
  s_branch L_fp0_1
L_last:
  s_endpgm
.section .rodata,"a"
.p2align 6
.amdhsa_kernel parallel_sum__ssm_conv_s5__geglu_ffn__prompt_kernel
  .amdhsa_next_free_vgpr 256
  .amdhsa_next_free_sgpr 102
  .amdhsa_accum_offset 256
  .amdhsa_group_segment_fixed_size 0
  .amdhsa_kernarg_size 128
  .amdhsa_user_sgpr_count 2
  .amdhsa_user_sgpr_kernarg_segment_ptr 1
  .amdhsa_system_sgpr_workgroup_id_x 1
  .amdhsa_float_denorm_mode_32 3
.end_amdhsa_kernel
```
